```python
import torch

def _softmax(x, axis=-1):
    return torch.softmax(x, dim=axis)
def _gelu(x):
    return torch.nn.functional.gelu(x, approximate="tanh")
def _silu(x):
    return torch.nn.functional.silu(x)
def _sigmoid(x):
    return torch.sigmoid(x)
def _layernorm(x, axis=-1, eps=1e-5):
    m = x.mean(dim=axis, keepdim=True)
    v = x.var(dim=axis, keepdim=True, unbiased=False)
    return (x - m) / torch.sqrt(v + eps)
def _scatter_add(tgt, idx, src, axis=0):
    return tgt.clone().index_add_(axis, idx, src)
def _segment_sum(src, seg, n):
    out = torch.zeros((n,) + src.shape[1:], dtype=src.dtype)
    return out.index_add_(0, seg, src)
def _pad(x, pw):
    flat = tuple(v for pair in reversed(pw) for v in pair)
    return torch.nn.functional.pad(x, flat)

kernel_name = 'recurrent_scan__ssm_conv_s5__dense_activation_silu__prompt'

def setup_inputs():

    _w = (lambda a: (lambda t: t.to(torch.bfloat16) if t.is_floating_point() else t)(torch.as_tensor(a)))
    def _A_setup():
        B, S, D = 1, 2048, 512
        P = D
        Lambda_re = -0.5 * (lambda _x: torch.exp(torch.as_tensor(_x)))((lambda *s: torch.randn(*s, dtype=torch.bfloat16) * 0.8)(P))
        Lambda_im = (lambda *s: torch.randn(*s, dtype=torch.bfloat16) * 0.8)(P) * 1.0
        B_re = (lambda *s: torch.randn(*s, dtype=torch.bfloat16) * 0.8)(P, D) * (D ** -0.5)
        B_im = (lambda *s: torch.randn(*s, dtype=torch.bfloat16) * 0.8)(P, D) * (D ** -0.5)
        C_re = (lambda *s: torch.randn(*s, dtype=torch.bfloat16) * 0.8)(D, P) * (P ** -0.5)
        C_im = (lambda *s: torch.randn(*s, dtype=torch.bfloat16) * 0.8)(D, P) * (P ** -0.5)
        log_dt = (lambda *s: torch.randn(*s, dtype=torch.bfloat16) * 0.8)(P) * 0.3 - 2.0
        Dskip = (lambda *s: torch.randn(*s, dtype=torch.bfloat16) * 0.8)(D)
        return {
            "x": _w((lambda *s: torch.randn(*s, dtype=torch.bfloat16) * 0.05)(B, S, D)),
            "Lambda_re": _w(Lambda_re),
            "Lambda_im": _w(Lambda_im),
            "B_re": _w(B_re),
            "B_im": _w(B_im),
            "C_re": _w(C_re),
            "C_im": _w(C_im),
            "log_dt": _w(log_dt),
            "Dskip": _w(Dskip),
        }
    _A_in = _A_setup()

    def _B_setup():
        B, S, D, F = 1, 2048, 512, 1792
        return {
            "x": _w((lambda *s: torch.randn(*s, dtype=torch.bfloat16) * 0.05)(B, S, D)),
            "w1": _w((lambda *s: torch.randn(*s, dtype=torch.bfloat16) * 0.8)(D, F) * (D ** -0.5)),
            "w2": _w((lambda *s: torch.randn(*s, dtype=torch.bfloat16) * 0.2)(F, D) * (F ** -0.5)),
        }
    _B_in = _B_setup()

    return {
        "A_x": _A_in["x"],
        "A_Lambda_re": _A_in["Lambda_re"],
        "A_Lambda_im": _A_in["Lambda_im"],
        "A_B_re": _A_in["B_re"],
        "A_B_im": _A_in["B_im"],
        "A_C_re": _A_in["C_re"],
        "A_C_im": _A_in["C_im"],
        "A_log_dt": _A_in["log_dt"],
        "A_Dskip": _A_in["Dskip"],
        "B_x": _B_in["x"],
        "B_w1": _B_in["w1"],
        "B_w2": _B_in["w2"],
    }

def reference(A_x, A_Lambda_re, A_Lambda_im, A_B_re, A_B_im, A_C_re, A_C_im, A_log_dt, A_Dskip, B_x, B_w1, B_w2):
    def _A_ref(x, Lambda_re, Lambda_im, B_re, B_im, C_re, C_im, log_dt, Dskip):
        Bsz, L, H = x.shape
        Lam = Lambda_re + 1j * Lambda_im
        Bmat = B_re + 1j * B_im
        Cmat = C_re + 1j * C_im
        dt = torch.exp(log_dt)
        Lam_bar = torch.exp(dt * Lam)
        B_bar = ((Lam_bar - 1.0) / Lam)[:, None] * Bmat
        Bu = torch.einsum("bld,pd->blp", x + 0j, B_bar)
        h = torch.zeros_like(Bu[:, 0, :])
        hs = []
        for t in range(L):
            h = Lam_bar[None, :] * h + Bu[:, t, :]
            hs.append(h)
        hseq = torch.stack(hs, 1)
        y = 2.0 * torch.einsum("blp,dp->bld", hseq, Cmat).real + x * Dskip[None, None, :]
        return y

    def _B_ref(x, w1, w2):
        h = torch.einsum("bsd,df->bsf", x, w1)
        h = _silu(h)
        out = torch.einsum("bsf,fd->bsd", h, w2)
        return out

    x = A_x
    xn = _layernorm(x, axis=-1)
    s = _A_ref(xn, A_Lambda_re, A_Lambda_im, A_B_re, A_B_im, A_C_re, A_C_im, A_log_dt, A_Dskip)
    g = _silu(_B_ref(xn, B_w1, B_w2))
    return x + s * g
```

```asm
; @launch grid=(256,1,1) block=(512,1,1) lds=163840
.amdgcn_target "amdgcn-amd-amdhsa--gfx950"
.text
.globl recurrent_scan__ssm_conv_s5__dense_activation_silu__prompt_kernel
.p2align 12
.type recurrent_scan__ssm_conv_s5__dense_activation_silu__prompt_kernel,@function
recurrent_scan__ssm_conv_s5__dense_activation_silu__prompt_kernel:
    s_cmp_ge_u32 s2, 256
    s_cbranch_scc1 KF_done
    s_load_dwordx16 s[72:87], s[0:1], 0
    s_load_dwordx4 s[88:91], s[0:1], 80
    s_load_dwordx2 s[94:95], s[0:1], 112
    s_memrealtime s[20:21]
    v_lshrrev_b32 v1, 6, v0
    v_and_b32 v2, 63, v0
    v_readfirstlane_b32 s34, v1
    v_and_b32 v14, 15, v2
    v_lshrrev_b32 v15, 4, v2
    v_lshlrev_b32 v1, 4, v2
    s_bfe_u32 s32, s2, 0x20001
    s_lshl_b32 s32, s32, 2
    s_bfe_u32 s48, s2, 0x20003
    s_add_u32 s32, s32, s48
    s_and_b32 s63, s2, 1
    s_lshl_b32 s33, s63, 3
    s_lshr_b32 s62, s2, 5
    s_add_u32 s33, s33, s62
    v_lshlrev_b32 v13, 10, v14
    v_lshl_add_u32 v13, v15, 4, v13
    s_lshl_b32 s48, s32, 3
    s_add_u32 s48, s48, s62
    s_lshl_b32 s48, s48, 14
    s_lshl_b32 s49, s34, 7
    s_add_u32 s55, s48, s49
    s_and_b32 s35, s34, 3
    s_lshr_b32 s36, s34, 2
    s_lshl_b32 s51, s34, 10
    s_lshl_b32 s52, s34, 14
    v_lshrrev_b32 v9, 3, v2
    v_and_b32 v10, 7, v2
    v_lshrrev_b32 v12, 1, v9
    s_and_b32 s48, s34, 1
    s_lshl_b32 s48, s48, 2
    v_or_b32 v12, s48, v12
    v_xor_b32 v12, v12, v10
    s_lshl_b32 s48, s35, 3
    s_lshl_b32 s49, s33, 5
    s_add_u32 s48, s48, s49
    v_add_u32 v9, s48, v9
    v_lshlrev_b32 v9, 10, v9
    v_lshl_add_u32 v128, v12, 4, v9
    s_lshl_b32 s48, s63, 9
    v_lshl_add_u32 v5, v0, 1, s48
    s_waitcnt lgkmcnt(0)
    s_mov_b32 s4, s72
    s_and_b32 s5, s73, 0xffff
    s_mov_b32 s6, 2097152
    s_mov_b32 s7, 0x00020000
    buffer_load_dwordx4 v[164:167], v13, s[4:7], s55 offen
    buffer_load_dwordx4 v[168:171], v13, s[4:7], s55 offen offset:64
    s_and_b32 s48, s32, 3
    s_lshl_b32 s48, s48, 1
    s_add_u32 s50, s33, s48
    s_cmp_lg_u32 s34, 1
    s_cbranch_scc1 KF_ncp
    s_getpc_b64 s[24:25]
KF_pc:
    s_and_b32 s25, s25, 0xffff
    s_mov_b32 s26, KF_done-KF_pc
    s_mov_b32 s27, 0x00020000
    s_bfe_u32 s48, s2, 0x20003
    s_lshl_b32 s48, s48, 7
    v_lshlrev_b32 v9, 9, v2
    buffer_load_dword v239, v9, s[24:27], s48 offen
KF_ncp:
    s_add_u32 s48, s50, 0
    s_and_b32 s48, s48, 7
    s_lshl_b32 s64, s48, 7
    s_add_u32 s48, s50, 1
    s_and_b32 s48, s48, 7
    s_lshl_b32 s65, s48, 7
    s_add_u32 s48, s50, 2
    s_and_b32 s48, s48, 7
    s_lshl_b32 s66, s48, 7
    s_add_u32 s48, s50, 3
    s_and_b32 s48, s48, 7
    s_lshl_b32 s67, s48, 7
    s_add_u32 s48, s50, 4
    s_and_b32 s48, s48, 7
    s_lshl_b32 s68, s48, 7
    s_add_u32 s48, s50, 5
    s_and_b32 s48, s48, 7
    s_lshl_b32 s69, s48, 7
    s_add_u32 s48, s50, 6
    s_and_b32 s48, s48, 7
    s_lshl_b32 s70, s48, 7
    s_add_u32 s48, s50, 7
    s_and_b32 s48, s48, 7
    s_lshl_b32 s71, s48, 7
    s_cmp_lt_u32 s34, 4
    s_cselect_b32 s48, s78, s80
    s_cselect_b32 s49, s79, s81
    s_mov_b32 s8, s48
    s_and_b32 s9, s49, 0xffff
    s_mov_b32 s10, 524288
    s_mov_b32 s11, 0x00020000
    s_add_u32 m0, s52, 0
    s_nop 0
    buffer_load_dwordx4 v128, s[8:11], s64 offen lds
    s_add_u32 m0, s52, 1024
    s_nop 0
    buffer_load_dwordx4 v128, s[8:11], s65 offen lds
    s_add_u32 m0, s52, 2048
    s_nop 0
    buffer_load_dwordx4 v128, s[8:11], s66 offen lds
    s_add_u32 m0, s52, 3072
    s_nop 0
    buffer_load_dwordx4 v128, s[8:11], s67 offen lds
    s_bfe_u32 s48, s33, 0x10002
    s_lshl_b32 s57, s32, 1
    s_add_u32 s57, s57, s48
    s_and_b32 s48, s33, 3
    s_lshl_b32 s59, s48, 3
    s_add_u32 s59, s59, s34
    s_lshl_b32 s48, s48, 1
    s_add_u32 s48, s48, s63
    s_lshl_b32 s3, s48, 5
    s_add_u32 s3, s3, s57
    s_lshl_b32 s101, s48, 8
    s_add_u32 s101, s101, 24248320
    s_sub_u32 s48, s57, 4
    s_cmp_ge_u32 s57, 28
    s_cselect_b32 s58, s48, s57
    s_lshr_b32 s48, s58, 1
    s_and_b32 s49, s58, 1
    s_sub_u32 s60, s58, 16
    s_cmp_ge_u32 s58, 16
    s_cselect_b32 s48, s60, s48
    s_cselect_b32 s49, 2, s49
    s_lshr_b32 s60, s48, 1
    s_mul_i32 s60, s60, 7
    s_and_b32 s48, s48, 1
    s_lshl_b32 s48, s48, 2
    s_add_u32 s60, s60, s48
    s_add_u32 s60, s60, s49
    s_sub_u32 s48, s58, 24
    s_mul_i32 s48, s48, 7
    s_add_u32 s48, s48, 3
    s_cmp_ge_u32 s58, 24
    s_cselect_b32 s60, s48, s60
    s_mul_i32 s48, s63, 28
    s_add_u32 s58, s58, s48
    s_add_u32 s60, s60, s48
    v_lshrrev_b32 v12, 1, v2
    v_lshlrev_b32 v12, 10, v12
    v_and_b32 v9, 1, v2
    v_lshl_add_u32 v12, v9, 4, v12
    s_lshl_b32 s60, s60, 15
    s_lshl_b32 s49, s59, 5
    s_add_u32 s60, s60, s49
    s_lshr_b32 s48, s3, 6
    s_lshl_b32 s48, s48, 3
    s_and_b32 s49, s3, 1
    s_lshl_b32 s49, s49, 2
    s_add_u32 s48, s48, s49
    s_add_u32 s48, s48, s35
    s_lshl_b32 s48, s48, 14
    s_bfe_u32 s49, s3, 0x40002
    s_lshl_b32 s49, s49, 6
    s_add_u32 s61, s48, s49
    s_cmp_lg_u32 s36, 0
    s_cbranch_scc1 KF_np
    s_mov_b32 s12, s74
    s_and_b32 s13, s75, 0xffff
    s_mov_b32 s14, 1024
    s_mov_b32 s15, 0x00020000
    s_mov_b32 s16, s76
    s_and_b32 s17, s77, 0xffff
    s_mov_b32 s18, 1024
    s_mov_b32 s19, 0x00020000
    s_mov_b32 s24, s86
    s_and_b32 s25, s87, 0xffff
    s_mov_b32 s26, 1024
    s_mov_b32 s27, 0x00020000
    buffer_load_ushort v6, v5, s[12:15], 0 offen
    buffer_load_ushort v7, v5, s[16:19], 0 offen
    buffer_load_ushort v11, v5, s[24:27], 0 offen
KF_np:
    s_mov_b32 s28, s90
    s_and_b32 s29, s91, 0xffff
    s_mov_b32 s30, 1835008
    s_mov_b32 s31, 0x00020000
    buffer_load_dwordx4 v[116:119], v12, s[28:31], s60 offen
    s_bitcmp0_b32 s3, 1
    s_cselect_b32 s48, s82, s84
    s_cselect_b32 s49, s83, s85
    s_mov_b32 s24, s48
    s_and_b32 s25, s49, 0xffff
    s_mov_b32 s26, 524288
    s_mov_b32 s27, 0x00020000
    buffer_load_dwordx4 v[120:123], v13, s[24:27], s61 offen
    s_mov_b32 s16, s94
    s_and_b32 s17, s95, 0xffff
    s_mov_b32 s18, 50331648
    s_mov_b32 s19, 0x00020000
    s_getreg_b32 s100, hwreg(HW_REG_XCC_ID, 0, 3)
    s_and_b32 s22, s20, -8
    s_or_b32 s100, s100, s22
    s_sub_u32 s20, s20, 800
    s_movk_i32 s22, 1600
    v_lshrrev_b32 v9, 2, v14
    v_cmp_eq_u32 vcc, v9, v15
    v_and_b32 v9, 1, v14
    v_lshlrev_b32 v9, 4, v9
    v_mov_b32 v10, 0x3f80
    v_lshlrev_b32 v9, v9, v10
    v_cndmask_b32 v9, 0, v9, vcc
    v_and_b32 v10, 2, v14
    v_cmp_eq_u32 vcc, 0, v10
    s_nop 1
    v_cndmask_b32 v106, 0, v9, vcc
    v_cndmask_b32 v107, v9, 0, vcc
    v_mov_b32 v104, 0
    v_mov_b32 v105, 0
    v_mov_b32 v108, 0
    v_mov_b32 v109, 0
    s_lshl_b32 s39, s32, 1
    s_add_u32 s39, s39, s63
    s_lshl_b32 s21, s39, 17
    s_add_u32 s21, s21, 4194304
    s_lshl_b32 s48, s62, 14
    s_add_u32 s55, s21, s48
    s_lshl_b32 s48, s34, 11
    s_add_u32 s55, s55, s48
    s_add_u32 s56, s55, 39845888
    v_lshlrev_b32 v10, 6, v14
    v_add_u32 v10, 152064, v10
    v_lshl_add_u32 v130, s34, 3, v10
KF_ret:
    s_mov_b32 s48, 0x3f803f80
    s_cmp_eq_u32 s36, 0
    s_cbranch_scc1 KF_xw
    s_waitcnt vmcnt(6)
KF_xw:
    s_waitcnt vmcnt(9)
    v_dot2_f32_bf16 v88, v164, s48, 0
    v_dot2_f32_bf16 v90, v164, v164, 0
    v_dot2_f32_bf16 v89, v165, s48, 0
    v_dot2_f32_bf16 v91, v165, v165, 0
    v_dot2_f32_bf16 v88, v166, s48, v88
    v_dot2_f32_bf16 v90, v166, v166, v90
    v_dot2_f32_bf16 v89, v167, s48, v89
    v_dot2_f32_bf16 v91, v167, v167, v91
    v_dot2_f32_bf16 v88, v168, s48, v88
    v_dot2_f32_bf16 v90, v168, v168, v90
    v_dot2_f32_bf16 v89, v169, s48, v89
    v_dot2_f32_bf16 v91, v169, v169, v91
    v_dot2_f32_bf16 v88, v170, s48, v88
    v_dot2_f32_bf16 v90, v170, v170, v90
    v_dot2_f32_bf16 v89, v171, s48, v89
    v_dot2_f32_bf16 v91, v171, v171, v91
    s_nop 1
    v_add_f32 v96, v88, v89
    v_add_f32 v97, v90, v91
    v_mov_b32 v98, v96
    v_mov_b32 v99, v97
    s_nop 0
    v_permlane16_swap_b32 v96, v98
    v_permlane16_swap_b32 v97, v99
    v_add_f32 v96, v96, v98
    v_add_f32 v97, v97, v99
    v_mov_b32 v98, v96
    v_mov_b32 v99, v97
    s_nop 0
    v_permlane32_swap_b32 v96, v98
    v_permlane32_swap_b32 v97, v99
    v_add_f32 v96, v96, v98
    v_add_f32 v97, v97, v99
    s_mov_b64 exec, 0xffff
    ds_write_b64 v130, v[96:97]
    v_mov_b32 v8, 151584
    v_mov_b32 v9, 0
    ds_write_b32 v8, v9
    s_mov_b64 exec, -1
    s_waitcnt lgkmcnt(0)
    s_barrier
    ds_read_b128 v[16:19], v10 offset:0
    ds_read_b128 v[20:23], v10 offset:16
    ds_read_b128 v[24:27], v10 offset:32
    ds_read_b128 v[28:31], v10 offset:48
    s_waitcnt lgkmcnt(3)
    v_pk_add_f32 v[16:17], v[16:17], v[18:19]
    s_waitcnt lgkmcnt(2)
    v_pk_add_f32 v[20:21], v[20:21], v[22:23]
    s_waitcnt lgkmcnt(1)
    v_pk_add_f32 v[24:25], v[24:25], v[26:27]
    s_waitcnt lgkmcnt(0)
    v_pk_add_f32 v[28:29], v[28:29], v[30:31]
    v_pk_add_f32 v[16:17], v[16:17], v[20:21]
    v_pk_add_f32 v[24:25], v[24:25], v[28:29]
    v_pk_add_f32 v[96:97], v[16:17], v[24:25]
    v_mul_f32 v96, 0x3b000000, v96
    v_mul_f32 v97, 0x3b000000, v97
    v_fma_f32 v97, -v96, v96, v97
    v_max_f32 v97, 0, v97
    v_cvt_pk_bf16_f32 v98, v96, v97
    v_lshlrev_b32 v80, 16, v98
    v_and_b32 v97, 0xffff0000, v98
    v_xor_b32 v84, 0x80000000, v80
    v_add_f32 v97, 0x3727c5ac, v97
    v_mov_b32 v85, v84
    v_cvt_pk_bf16_f32 v97, v97, v97
    v_mov_b32 v86, v84
    v_lshlrev_b32 v97, 16, v97
    v_mov_b32 v87, v84
    v_sqrt_f32 v97, v97
    s_nop 0
    v_cvt_pk_bf16_f32 v97, v97, v97
    v_lshlrev_b32 v97, 16, v97
    v_rcp_f32 v98, v97
    s_nop 0
    v_fma_f32 v99, -v97, v98, 2.0
    v_mul_f32 v81, v98, v99
    v_mfma_f32_16x16x32_bf16 v[88:91], v[106:109], v[164:167], v[84:87]
    v_mfma_f32_16x16x32_bf16 v[92:95], v[104:107], v[164:167], v[84:87]
    v_mfma_f32_16x16x32_bf16 v[96:99], v[106:109], v[168:171], v[84:87]
    v_mfma_f32_16x16x32_bf16 v[100:103], v[104:107], v[168:171], v[84:87]
    s_nop 4
    v_cvt_pk_bf16_f32 v88, 0, v88
    v_cvt_pk_bf16_f32 v89, 0, v89
    v_cvt_pk_bf16_f32 v90, 0, v90
    v_cvt_pk_bf16_f32 v91, 0, v91
    v_cvt_pk_bf16_f32 v92, 0, v92
    v_cvt_pk_bf16_f32 v93, 0, v93
    v_cvt_pk_bf16_f32 v94, 0, v94
    v_cvt_pk_bf16_f32 v95, 0, v95
    v_pk_mul_f32 v[88:89], v[88:89], v[80:81] op_sel:[0,1] op_sel_hi:[1,1]
    v_pk_mul_f32 v[90:91], v[90:91], v[80:81] op_sel:[0,1] op_sel_hi:[1,1]
    v_pk_mul_f32 v[92:93], v[92:93], v[80:81] op_sel:[0,1] op_sel_hi:[1,1]
    v_pk_mul_f32 v[94:95], v[94:95], v[80:81] op_sel:[0,1] op_sel_hi:[1,1]
    v_cvt_pk_bf16_f32 v164, v88, v89
    v_cvt_pk_bf16_f32 v165, v90, v91
    v_cvt_pk_bf16_f32 v166, v92, v93
    v_cvt_pk_bf16_f32 v167, v94, v95
    buffer_store_dwordx4 v[164:167], v1, s[16:19], s55 offen offset:0 sc1
    v_cvt_pk_bf16_f32 v96, 0, v96
    v_cvt_pk_bf16_f32 v97, 0, v97
    v_cvt_pk_bf16_f32 v98, 0, v98
    v_cvt_pk_bf16_f32 v99, 0, v99
    v_cvt_pk_bf16_f32 v100, 0, v100
    v_cvt_pk_bf16_f32 v101, 0, v101
    v_cvt_pk_bf16_f32 v102, 0, v102
    v_cvt_pk_bf16_f32 v103, 0, v103
    v_pk_mul_f32 v[96:97], v[96:97], v[80:81] op_sel:[0,1] op_sel_hi:[1,1]
    v_pk_mul_f32 v[98:99], v[98:99], v[80:81] op_sel:[0,1] op_sel_hi:[1,1]
    v_pk_mul_f32 v[100:101], v[100:101], v[80:81] op_sel:[0,1] op_sel_hi:[1,1]
    v_pk_mul_f32 v[102:103], v[102:103], v[80:81] op_sel:[0,1] op_sel_hi:[1,1]
    v_cvt_pk_bf16_f32 v168, v96, v97
    v_cvt_pk_bf16_f32 v169, v98, v99
    v_cvt_pk_bf16_f32 v170, v100, v101
    v_cvt_pk_bf16_f32 v171, v102, v103
    buffer_store_dwordx4 v[168:171], v1, s[16:19], s55 offen offset:1024 sc1
    s_mov_b32 s12, s88
    s_and_b32 s13, s89, 0xffff
    s_mov_b32 s14, 1835008
    s_mov_b32 s15, 0x00020000
    s_and_b32 s48, s34, 1
    s_lshl_b32 s48, s48, 2
    v_or_b32 v12, s48, v15
    v_bfe_u32 v9, v2, 1, 3
    v_xor_b32 v12, v12, v9
    v_lshlrev_b32 v12, 5, v12
    v_and_b32 v9, 1, v2
    v_lshl_add_u32 v9, v9, 4, v12
    s_lshl_b32 s48, s34, 3
    v_add_u32 v12, s48, v15
    s_movk_i32 s49, 3584
    v_mul_lo_u32 v12, v12, s49
    s_mul_i32 s48, s33, 224
    v_add3_u32 v234, v12, v9, s48
    s_lshl_b32 s39, s39, 11
    s_add_u32 s39, s39, 24117248
    s_lshl_b32 s48, s62, 5
    s_lshl_b32 s49, s34, 2
    s_add_u32 s48, s48, s49
    s_add_u32 s53, s39, s48
    s_lshl_b32 s48, s34, 5
    s_add_u32 s38, s39, s48
    s_cmp_lg_u32 s34, 6
    s_cbranch_scc1 KF_nz0
    v_mov_b32 v16, 0
    v_mov_b32 v17, 0
    v_mov_b32 v18, 0
    v_mov_b32 v19, 0
    v_add_u32 v9, 153088, v1
    ds_write_b128 v9, v[16:19]
    ds_write_b128 v9, v[16:19] offset:1024
    v_mov_b32 v9, 151552
    ds_write_b128 v9, v[16:19]
    ds_write_b128 v9, v[16:19] offset:16
KF_nz0:
    v_mov_b32 v244, 0
    v_mov_b32 v245, 0
    v_mov_b32 v246, 0
    v_mov_b32 v247, 0
    v_bfe_u32 v12, v14, 1, 3
    v_xor_b32 v12, v12, v15
    v_and_b32 v13, 7, v14
    v_lshlrev_b32 v13, 7, v13
    v_lshrrev_b32 v9, 3, v14
    v_lshl_add_u32 v13, v9, 14, v13
    v_lshl_add_u32 v110, v12, 4, v13
    v_xor_b32 v111, 64, v110
    v_add_u32 v112, 65536, v110
    v_add_u32 v113, 65536, v111
    s_add_u32 s23, s21, s52
    s_lshl_b32 s49, s62, 2
    s_add_u32 s37, s39, s49
    s_lshl_b32 s47, s33, 13
    s_lshl_b32 s49, s32, 9
    s_add_u32 s47, s47, s49
    s_add_u32 s47, s47, 22020096
    s_lshl_b32 s48, s62, 8
    s_add_u32 s48, s48, 131072
    v_lshl_add_u32 v129, v14, 4, s48
    v_and_b32 v3, 7, v2
    v_lshlrev_b32 v3, 2, v3
    v_bfe_u32 v12, v2, 2, 2
    v_and_b32 v13, 1, v15
    v_lshl_or_b32 v13, v13, 2, v12
    v_lshlrev_b32 v12, 8, v12
    v_lshl_add_u32 v12, v15, 14, v12
    v_and_b32 v4, 3, v2
    v_lshl_add_u32 v12, v4, 3, v12
    s_and_b32 s54, s33, 1
    s_cmp_lg_u32 s54, 0
    s_cselect_b32 s56, 0, 6
    s_add_u32 s48, s54, 0
    v_xor_b32 v4, s48, v13
    v_lshl_add_u32 v220, v4, 5, v12
    v_add_u32 v227, 65536, v220
    s_add_u32 s48, s54, 1
    v_xor_b32 v4, s48, v13
    v_lshl_add_u32 v221, v4, 5, v12
    v_add_u32 v228, 65536, v221
    s_add_u32 s48, s54, 2
    v_xor_b32 v4, s48, v13
    v_lshl_add_u32 v222, v4, 5, v12
    v_add_u32 v229, 65536, v222
    s_add_u32 s48, s54, 3
    v_xor_b32 v4, s48, v13
    v_lshl_add_u32 v223, v4, 5, v12
    v_add_u32 v230, 65536, v223
    s_add_u32 s48, s54, 4
    v_xor_b32 v4, s48, v13
    v_lshl_add_u32 v224, v4, 5, v12
    v_add_u32 v231, 65536, v224
    s_add_u32 s48, s54, 5
    v_xor_b32 v4, s48, v13
    v_lshl_add_u32 v225, v4, 5, v12
    v_add_u32 v232, 65536, v225
    v_xor_b32 v4, s56, v13
    v_lshl_add_u32 v226, v4, 5, v12
    v_add_u32 v233, 65536, v226
    v_mov_b32 v9, s100
    v_mov_b32 v8, 0
    s_waitcnt vmcnt(0)
    s_mov_b64 exec, 1
    buffer_store_dword v9, v8, s[16:19], s53 offen offset:1024
    v_mov_b32 v8, 151584
    v_mov_b32 v9, 1
    ds_add_rtn_u32 v246, v8, v9
    s_mov_b64 exec, -1
    s_cmp_lg_u32 s36, 0
    s_cbranch_scc1 KF_ntab
    s_waitcnt vmcnt(5)
    v_lshlrev_b32 v137, 16, v7
    v_lshlrev_b32 v136, 16, v6
    v_lshlrev_b32 v138, 16, v11
    v_mul_f32 v138, 0x3fb8aa3b, v138
    v_exp_f32 v138, v138
    s_nop 0
    v_cvt_pk_bf16_f32 v138, v138, v138
    v_lshlrev_b32 v138, 16, v138
    v_mul_f32 v139, v138, v136
    v_mul_f32 v140, v138, v137
    v_mul_f32 v139, 0x3fb8aa3b, v139
    v_exp_f32 v139, v139
    v_mul_f32 v141, 0x3f22f983, v140
    v_rndne_f32 v141, v141
    v_mov_b32 v142, 0x3fc90000
    v_fma_f32 v140, -v141, v142, v140
    v_mov_b32 v142, 0x39fda000
    v_fma_f32 v140, -v141, v142, v140
    v_mov_b32 v142, 0x33a22169
    v_fma_f32 v140, -v141, v142, v140
    v_cvt_i32_f32 v141, v141
    v_mul_f32 v142, v140, v140
    v_mov_b32 v143, 0xb94ca1f9
    v_mov_b32 v144, 0x3c08839e
    v_fma_f32 v143, v143, v142, v144
    v_mov_b32 v144, 0xbe2aaaa3
    v_fma_f32 v143, v143, v142, v144
    v_mul_f32 v143, v143, v142
    v_fma_f32 v143, v143, v140, v140
    v_mov_b32 v144, 0x37ccf5ce
    v_mov_b32 v145, 0xbab6061a
    v_fma_f32 v144, v144, v142, v145
    v_mov_b32 v145, 0x3d2aaaa5
    v_fma_f32 v144, v144, v142, v145
    v_mul_f32 v144, v144, v142
    v_fma_f32 v144, v144, v142, 1.0
    v_fma_f32 v144, v142, -0.5, v144
    v_and_b32 v145, 1, v141
    v_cmp_eq_u32 vcc, 1, v145
    s_nop 1
    v_cndmask_b32 v146, v143, v144, vcc
    v_cndmask_b32 v147, v144, v143, vcc
    v_lshlrev_b32 v145, 30, v141
    v_and_b32 v145, 0x80000000, v145
    v_xor_b32 v146, v146, v145
    v_add_u32 v145, 1, v141
    v_lshlrev_b32 v145, 30, v145
    v_and_b32 v145, 0x80000000, v145
    v_xor_b32 v147, v147, v145
    v_mul_f32 v148, v139, v147
    v_mul_f32 v149, v139, v146
    v_lshrrev_b32 v4, 5, v0
    v_lshlrev_b32 v4, 8, v4
    v_lshl_add_u32 v4, v14, 4, v4
    v_and_b32 v8, 1, v15
    v_lshl_add_u32 v4, v8, 3, v4
    v_add_u32 v4, 131072, v4
    ds_write_b64 v4, v[148:149]
    v_mul_f32 v166, v149, v149
    v_mul_f32 v153, v148, v149
    v_fma_f32 v152, v148, v148, -v166
    v_add_f32 v153, v153, v153
    v_mul_f32 v166, v153, v153
    v_mul_f32 v155, v152, v153
    v_fma_f32 v154, v152, v152, -v166
    v_add_f32 v155, v155, v155
    ds_write_b64 v4, v[154:155] offset:4096
    v_mul_f32 v166, v155, v155
    v_mul_f32 v157, v154, v155
    v_fma_f32 v156, v154, v154, -v166
    v_add_f32 v157, v157, v157
    ds_write_b64 v4, v[156:157] offset:6144
    v_mul_f32 v166, v157, v157
    v_mul_f32 v159, v156, v157
    v_fma_f32 v158, v156, v156, -v166
    v_add_f32 v159, v159, v159
    ds_write_b64 v4, v[158:159] offset:10240
    v_mul_f32 v166, v159, v159
    v_mul_f32 v161, v158, v159
    v_fma_f32 v160, v158, v158, -v166
    v_add_f32 v161, v161, v161
    ds_write_b64 v4, v[160:161] offset:12288
    v_mul_f32 v166, v161, v161
    v_mul_f32 v163, v160, v161
    v_fma_f32 v162, v160, v160, -v166
    v_add_f32 v163, v163, v163
    ds_write_b64 v4, v[162:163] offset:16384
    v_mul_f32 v166, v163, v163
    v_mul_f32 v165, v162, v163
    v_fma_f32 v164, v162, v162, -v166
    v_add_f32 v165, v165, v165
    ds_write_b64 v4, v[164:165] offset:18432
    v_pk_mul_f32 v[168:169], v[154:155], v[156:157] op_sel_hi:[1,0]
    v_pk_fma_f32 v[168:169], v[154:155], v[156:157], v[168:169] op_sel:[1,1,0] op_sel_hi:[0,1,1] neg_lo:[0,1,0]
    ds_write_b64 v4, v[168:169] offset:8192
    v_pk_mul_f32 v[170:171], v[158:159], v[160:161] op_sel_hi:[1,0]
    v_pk_fma_f32 v[170:171], v[158:159], v[160:161], v[170:171] op_sel:[1,1,0] op_sel_hi:[0,1,1] neg_lo:[0,1,0]
    ds_write_b64 v4, v[170:171] offset:14336
    v_add_f32 v140, -1.0, v148
    v_mul_f32 v141, v149, v137
    v_fma_f32 v141, v140, v136, v141
    v_mul_f32 v142, v140, v137
    v_fma_f32 v142, v149, v136, -v142
    v_mul_f32 v143, v137, v137
    v_fma_f32 v143, v136, v136, v143
    v_rcp_f32 v144, v143
    s_nop 0
    v_fma_f32 v145, -v143, v144, 2.0
    v_mul_f32 v144, v144, v145
    v_mul_f32 v150, v141, v144
    v_mul_f32 v151, v142, v144
    ds_write_b64 v4, v[150:151] offset:2048
KF_ntab:
    s_nop 7
    s_nop 3
    s_add_u32 m0, s52, 4096
    s_nop 0
    buffer_load_dwordx4 v128, s[8:11], s68 offen lds
    s_add_u32 m0, s52, 5120
    s_nop 0
    buffer_load_dwordx4 v128, s[8:11], s69 offen lds
    s_add_u32 m0, s52, 6144
    s_nop 0
    buffer_load_dwordx4 v128, s[8:11], s70 offen lds
    s_add_u32 m0, s52, 7168
    s_nop 0
    buffer_load_dwordx4 v128, s[8:11], s71 offen lds
    buffer_load_dword v11, v3, s[16:19], s38 offen offset:1024 sc1
    s_movk_i32 s61, 16384
    s_waitcnt vmcnt(0)
KF_pxl:
    v_subrev_u32 v10, s20, v11
    v_cmp_lt_u32 vcc, s22, v10
    s_cbranch_vccz KF_pxd
    s_sub_u32 s61, s61, 1
    s_cbranch_scc1 KF_pxd
    s_and_b32 s48, s61, 7
    s_cmp_lg_u32 s48, 4
    s_cbranch_scc1 KF_pxg
    s_waitcnt lgkmcnt(0)
    v_readfirstlane_b32 s48, v246
    v_mov_b32 v9, s100
    v_lshlrev_b32 v8, 2, v2
    s_andn2_b32 s49, s53, 31
    s_cmp_eq_u32 s48, 7
    s_cselect_b32 s49, s49, 50331648
    s_mov_b64 exec, 0xff
    buffer_store_dword v9, v8, s[16:19], s49 offen offset:1280 sc1
    s_mov_b64 exec, -1
KF_pxg:
    s_add_u32 s49, s38, 256
    s_and_b32 s48, s61, 7
    s_cselect_b32 s48, s38, s49
    buffer_load_dword v11, v3, s[16:19], s48 offen offset:1024 sc1
    s_waitcnt vmcnt(0)
    s_branch KF_pxl
KF_st0:
    s_branch KF_ret
KF_pxd:
    s_lshl_b32 s48, s64, 4
    s_add_u32 s48, s48, s23
    buffer_load_dwordx4 v[16:19], v1, s[16:19], s48 offen offset:0
    buffer_load_dwordx4 v[20:23], v1, s[16:19], s48 offen offset:1024
    s_lshl_b32 s48, s65, 4
    s_add_u32 s48, s48, s23
    buffer_load_dwordx4 v[24:27], v1, s[16:19], s48 offen offset:0
    buffer_load_dwordx4 v[28:31], v1, s[16:19], s48 offen offset:1024
    s_lshl_b32 s48, s66, 4
    s_add_u32 s48, s48, s23
    buffer_load_dwordx4 v[32:35], v1, s[16:19], s48 offen offset:0
    buffer_load_dwordx4 v[36:39], v1, s[16:19], s48 offen offset:1024
    s_lshl_b32 s48, s67, 4
    s_add_u32 s48, s48, s23
    buffer_load_dwordx4 v[40:43], v1, s[16:19], s48 offen offset:0
    buffer_load_dwordx4 v[44:47], v1, s[16:19], s48 offen offset:1024
    s_lshl_b32 s48, s68, 4
    s_add_u32 s48, s48, s23
    buffer_load_dwordx4 v[48:51], v1, s[16:19], s48 offen offset:0
    buffer_load_dwordx4 v[52:55], v1, s[16:19], s48 offen offset:1024
    s_lshl_b32 s48, s69, 4
    s_add_u32 s48, s48, s23
    buffer_load_dwordx4 v[56:59], v1, s[16:19], s48 offen offset:0
    buffer_load_dwordx4 v[60:63], v1, s[16:19], s48 offen offset:1024
    s_lshl_b32 s48, s70, 4
    s_add_u32 s48, s48, s23
    buffer_load_dwordx4 v[64:67], v1, s[16:19], s48 offen offset:0
    buffer_load_dwordx4 v[68:71], v1, s[16:19], s48 offen offset:1024
    s_lshl_b32 s48, s71, 4
    s_add_u32 s48, s48, s23
    buffer_load_dwordx4 v[72:75], v1, s[16:19], s48 offen offset:0
    buffer_load_dwordx4 v[76:79], v1, s[16:19], s48 offen offset:1024
    s_add_u32 s48, s51, 155136
    v_add_u32 v8, s48, v1
    s_mul_i32 s60, s63, 28
    s_sub_u32 s60, s58, s60
    s_cmp_ge_u32 s60, 24
    s_cselect_b32 s60, 3, 2
    s_cselect_b32 s61, 1, 4
    s_lshl_b32 s61, s61, 7
    v_bfe_u32 v9, v2, 2, 2
    v_lshl_add_u32 v9, v15, s60, v9
    v_lshlrev_b32 v9, 5, v9
    v_and_b32 v10, 3, v2
    v_lshl_add_u32 v9, v10, 3, v9
    v_add_u32 v9, s48, v9
    v_add_u32 v10, s61, v9
    s_lshl_b32 s38, s32, 4
    s_add_u32 s38, s38, s33
    s_waitcnt vmcnt(24)
    ds_write_b128 v8, v[116:119]
    ds_read_b64_tr_b16 v[116:117], v9
    ds_read_b64_tr_b16 v[118:119], v10
    v_lshlrev_b32 v88, 16, v120
    v_and_b32 v89, 0xffff0000, v120
    v_cvt_pk_f16_f32 v120, v88, v89
    v_lshlrev_b32 v88, 16, v121
    v_and_b32 v89, 0xffff0000, v121
    v_cvt_pk_f16_f32 v121, v88, v89
    v_lshlrev_b32 v88, 16, v122
    v_and_b32 v89, 0xffff0000, v122
    v_cvt_pk_f16_f32 v122, v88, v89
    v_lshlrev_b32 v88, 16, v123
    v_and_b32 v89, 0xffff0000, v123
    v_cvt_pk_f16_f32 v123, v88, v89
    s_lshl_b32 s48, s3, 12
    s_lshl_b32 s49, s35, 10
    s_add_u32 s48, s48, s49
    s_add_u32 s48, s48, 23068672
    s_cmp_lg_u32 s36, 0
    s_cselect_b32 s48, s48, 50331648
    buffer_store_dwordx4 v[120:123], v1, s[16:19], s48 offen sc1
    s_mul_i32 s48, s59, 57344
    s_lshl_b32 s49, s58, 10
    s_add_u32 s48, s48, s49
    s_add_u32 s48, s48, 18874368
    s_waitcnt lgkmcnt(0)
    buffer_store_dwordx4 v[116:119], v1, s[16:19], s48 offen sc1
    s_waitcnt lgkmcnt(0)
    v_readfirstlane_b32 s48, v246
    v_mov_b32 v9, s100
    v_lshlrev_b32 v8, 2, v2
    s_andn2_b32 s49, s53, 31
    s_cmp_eq_u32 s48, 7
    s_cselect_b32 s49, s49, 50331648
    s_mov_b64 exec, 0xff
    buffer_store_dword v9, v8, s[16:19], s49 offen offset:1280 sc1
    s_mov_b64 exec, -1
    s_waitcnt vmcnt(20)
    s_barrier
    ds_read_b128 v[148:151], v110 offset:0
    ds_read_b128 v[152:155], v110 offset:32768
    ds_read_b128 v[156:159], v112 offset:0
    ds_read_b128 v[160:163], v112 offset:32768
    ds_read_b128 v[88:91], v111 offset:0
    ds_read_b128 v[92:95], v111 offset:32768
    ds_read_b128 v[96:99], v113 offset:0
    ds_read_b128 v[100:103], v113 offset:32768
    v_lshl_add_u32 v4, v15, 11, v129
    s_lshl_b32 s48, s35, 11
    v_add_u32 v5, s48, v129
    ds_read_b128 v[188:191], v129
    ds_read_b128 v[192:195], v129 offset:2048
    ds_read_b128 v[196:199], v129 offset:4096
    ds_read_b128 v[200:203], v129 offset:10240
    ds_read_b128 v[208:211], v4 offset:2048
    ds_read_b128 v[212:215], v5 offset:8192
    ds_read_b128 v[216:219], v129 offset:16384
    s_waitcnt vmcnt(18) lgkmcnt(11)
    v_mfma_f32_16x16x32_bf16 v[132:135], v[16:19], v[148:151], 0
    ds_read_b128 v[164:167], v110 offset:1024
    v_mfma_f32_16x16x32_bf16 v[136:139], v[16:19], v[152:155], 0
    ds_read_b128 v[168:171], v110 offset:33792
    v_mfma_f32_16x16x32_bf16 v[140:143], v[16:19], v[156:159], 0
    ds_read_b128 v[172:175], v112 offset:1024
    v_mfma_f32_16x16x32_bf16 v[144:147], v[16:19], v[160:163], 0
    ds_read_b128 v[176:179], v112 offset:33792
    s_add_u32 m0, s52, 8192
    s_mul_i32 s49, s64, 1792
    buffer_load_dwordx4 v234, s[12:15], s49 offen lds
    s_mul_i32 s49, s64, 1792
    s_add_u32 m0, s52, 9216
    s_add_u32 s49, s49, 14336
    buffer_load_dwordx4 v234, s[12:15], s49 offen lds
    s_waitcnt vmcnt(19) lgkmcnt(11)
    v_mfma_f32_16x16x32_bf16 v[132:135], v[20:23], v[88:91], v[132:135]
    ds_read_b128 v[148:151], v111 offset:1024
    v_mfma_f32_16x16x32_bf16 v[136:139], v[20:23], v[92:95], v[136:139]
    ds_read_b128 v[152:155], v111 offset:33792
    v_mfma_f32_16x16x32_bf16 v[140:143], v[20:23], v[96:99], v[140:143]
    ds_read_b128 v[156:159], v113 offset:1024
    v_mfma_f32_16x16x32_bf16 v[144:147], v[20:23], v[100:103], v[144:147]
    ds_read_b128 v[160:163], v113 offset:33792
    s_add_u32 m0, s52, 10240
    s_mul_i32 s49, s65, 1792
    buffer_load_dwordx4 v234, s[12:15], s49 offen lds
    s_mul_i32 s49, s65, 1792
    s_add_u32 m0, s52, 11264
    s_add_u32 s49, s49, 14336
    buffer_load_dwordx4 v234, s[12:15], s49 offen lds
    s_waitcnt vmcnt(20) lgkmcnt(4)
    v_mfma_f32_16x16x32_bf16 v[132:135], v[24:27], v[164:167], v[132:135]
    ds_read_b128 v[88:91], v110 offset:2048
    v_mfma_f32_16x16x32_bf16 v[136:139], v[24:27], v[168:171], v[136:139]
    ds_read_b128 v[92:95], v110 offset:34816
    v_mfma_f32_16x16x32_bf16 v[140:143], v[24:27], v[172:175], v[140:143]
    ds_read_b128 v[96:99], v112 offset:2048
    v_mfma_f32_16x16x32_bf16 v[144:147], v[24:27], v[176:179], v[144:147]
    ds_read_b128 v[100:103], v112 offset:34816
    s_add_u32 m0, s52, 12288
    s_mul_i32 s49, s66, 1792
    buffer_load_dwordx4 v234, s[12:15], s49 offen lds
    s_waitcnt vmcnt(20) lgkmcnt(4)
    v_mfma_f32_16x16x32_bf16 v[132:135], v[28:31], v[148:151], v[132:135]
    ds_read_b128 v[164:167], v111 offset:2048
    v_mfma_f32_16x16x32_bf16 v[136:139], v[28:31], v[152:155], v[136:139]
    ds_read_b128 v[168:171], v111 offset:34816
    v_mfma_f32_16x16x32_bf16 v[140:143], v[28:31], v[156:159], v[140:143]
    ds_read_b128 v[172:175], v113 offset:2048
    v_mfma_f32_16x16x32_bf16 v[144:147], v[28:31], v[160:163], v[144:147]
    ds_read_b128 v[176:179], v113 offset:34816
    s_mul_i32 s49, s66, 1792
    s_add_u32 m0, s52, 13312
    s_add_u32 s49, s49, 14336
    buffer_load_dwordx4 v234, s[12:15], s49 offen lds
    s_waitcnt vmcnt(20) lgkmcnt(4)
    v_mfma_f32_16x16x32_bf16 v[132:135], v[32:35], v[88:91], v[132:135]
    ds_read_b128 v[148:151], v110 offset:3072
    v_mfma_f32_16x16x32_bf16 v[136:139], v[32:35], v[92:95], v[136:139]
    ds_read_b128 v[152:155], v110 offset:35840
    v_mfma_f32_16x16x32_bf16 v[140:143], v[32:35], v[96:99], v[140:143]
    ds_read_b128 v[156:159], v112 offset:3072
    v_mfma_f32_16x16x32_bf16 v[144:147], v[32:35], v[100:103], v[144:147]
    ds_read_b128 v[160:163], v112 offset:35840
    s_add_u32 m0, s52, 14336
    s_mul_i32 s49, s67, 1792
    buffer_load_dwordx4 v234, s[12:15], s49 offen lds
    s_waitcnt vmcnt(20) lgkmcnt(4)
    v_mfma_f32_16x16x32_bf16 v[132:135], v[36:39], v[164:167], v[132:135]
    ds_read_b128 v[88:91], v111 offset:3072
    v_mfma_f32_16x16x32_bf16 v[136:139], v[36:39], v[168:171], v[136:139]
    ds_read_b128 v[92:95], v111 offset:35840
    v_mfma_f32_16x16x32_bf16 v[140:143], v[36:39], v[172:175], v[140:143]
    ds_read_b128 v[96:99], v113 offset:3072
    v_mfma_f32_16x16x32_bf16 v[144:147], v[36:39], v[176:179], v[144:147]
    ds_read_b128 v[100:103], v113 offset:35840
    s_mul_i32 s49, s67, 1792
    s_add_u32 m0, s52, 15360
    s_add_u32 s49, s49, 14336
    buffer_load_dwordx4 v234, s[12:15], s49 offen lds
    s_waitcnt vmcnt(20) lgkmcnt(4)
    v_mfma_f32_16x16x32_bf16 v[132:135], v[40:43], v[148:151], v[132:135]
    ds_read_b128 v[164:167], v110 offset:4096
    v_mfma_f32_16x16x32_bf16 v[136:139], v[40:43], v[152:155], v[136:139]
    ds_read_b128 v[168:171], v110 offset:36864
    v_mfma_f32_16x16x32_bf16 v[140:143], v[40:43], v[156:159], v[140:143]
    ds_read_b128 v[172:175], v112 offset:4096
    v_mfma_f32_16x16x32_bf16 v[144:147], v[40:43], v[160:163], v[144:147]
    ds_read_b128 v[176:179], v112 offset:36864
    s_waitcnt vmcnt(19) lgkmcnt(4)
    s_barrier
    s_add_u32 m0, s52, 0
    s_mul_i32 s49, s68, 1792
    buffer_load_dwordx4 v234, s[12:15], s49 offen lds
    s_mul_i32 s49, s68, 1792
    s_add_u32 m0, s52, 1024
    s_add_u32 s49, s49, 14336
    buffer_load_dwordx4 v234, s[12:15], s49 offen lds
    v_mfma_f32_16x16x32_bf16 v[132:135], v[44:47], v[88:91], v[132:135]
    ds_read_b128 v[148:151], v111 offset:4096
    v_mfma_f32_16x16x32_bf16 v[136:139], v[44:47], v[92:95], v[136:139]
    ds_read_b128 v[152:155], v111 offset:36864
    v_mfma_f32_16x16x32_bf16 v[140:143], v[44:47], v[96:99], v[140:143]
    ds_read_b128 v[156:159], v113 offset:4096
    v_mfma_f32_16x16x32_bf16 v[144:147], v[44:47], v[100:103], v[144:147]
    ds_read_b128 v[160:163], v113 offset:36864
    s_waitcnt vmcnt(20) lgkmcnt(4)
    v_mfma_f32_16x16x32_bf16 v[132:135], v[48:51], v[164:167], v[132:135]
    ds_read_b128 v[88:91], v110 offset:5120
    v_mfma_f32_16x16x32_bf16 v[136:139], v[48:51], v[168:171], v[136:139]
    ds_read_b128 v[92:95], v110 offset:37888
    v_mfma_f32_16x16x32_bf16 v[140:143], v[48:51], v[172:175], v[140:143]
    ds_read_b128 v[96:99], v112 offset:5120
    v_mfma_f32_16x16x32_bf16 v[144:147], v[48:51], v[176:179], v[144:147]
    ds_read_b128 v[100:103], v112 offset:37888
    s_add_u32 m0, s52, 2048
    s_mul_i32 s49, s69, 1792
    buffer_load_dwordx4 v234, s[12:15], s49 offen lds
    s_mul_i32 s49, s69, 1792
    s_add_u32 m0, s52, 3072
    s_add_u32 s49, s49, 14336
    buffer_load_dwordx4 v234, s[12:15], s49 offen lds
    s_waitcnt vmcnt(21) lgkmcnt(4)
    v_mfma_f32_16x16x32_bf16 v[132:135], v[52:55], v[148:151], v[132:135]
    ds_read_b128 v[164:167], v111 offset:5120
    v_mfma_f32_16x16x32_bf16 v[136:139], v[52:55], v[152:155], v[136:139]
    ds_read_b128 v[168:171], v111 offset:37888
    v_mfma_f32_16x16x32_bf16 v[140:143], v[52:55], v[156:159], v[140:143]
    ds_read_b128 v[172:175], v113 offset:5120
    v_mfma_f32_16x16x32_bf16 v[144:147], v[52:55], v[160:163], v[144:147]
    ds_read_b128 v[176:179], v113 offset:37888
    s_waitcnt vmcnt(20) lgkmcnt(4)
    v_mfma_f32_16x16x32_bf16 v[132:135], v[56:59], v[88:91], v[132:135]
    ds_read_b128 v[148:151], v110 offset:6144
    v_mfma_f32_16x16x32_bf16 v[136:139], v[56:59], v[92:95], v[136:139]
    ds_read_b128 v[152:155], v110 offset:38912
    v_mfma_f32_16x16x32_bf16 v[140:143], v[56:59], v[96:99], v[140:143]
    ds_read_b128 v[156:159], v112 offset:6144
    v_mfma_f32_16x16x32_bf16 v[144:147], v[56:59], v[100:103], v[144:147]
    ds_read_b128 v[160:163], v112 offset:38912
    s_waitcnt vmcnt(19) lgkmcnt(4)
    v_mfma_f32_16x16x32_bf16 v[132:135], v[60:63], v[164:167], v[132:135]
    ds_read_b128 v[88:91], v111 offset:6144
    v_mfma_f32_16x16x32_bf16 v[136:139], v[60:63], v[168:171], v[136:139]
    ds_read_b128 v[92:95], v111 offset:38912
    v_mfma_f32_16x16x32_bf16 v[140:143], v[60:63], v[172:175], v[140:143]
    ds_read_b128 v[96:99], v113 offset:6144
    v_mfma_f32_16x16x32_bf16 v[144:147], v[60:63], v[176:179], v[144:147]
    ds_read_b128 v[100:103], v113 offset:38912
    s_barrier
    s_add_u32 m0, s52, 4096
    s_mul_i32 s49, s70, 1792
    buffer_load_dwordx4 v234, s[12:15], s49 offen lds
    s_mul_i32 s49, s70, 1792
    s_add_u32 m0, s52, 5120
    s_add_u32 s49, s49, 14336
    buffer_load_dwordx4 v234, s[12:15], s49 offen lds
    s_waitcnt vmcnt(20) lgkmcnt(4)
    v_mfma_f32_16x16x32_bf16 v[132:135], v[64:67], v[148:151], v[132:135]
    ds_read_b128 v[164:167], v110 offset:7168
    v_mfma_f32_16x16x32_bf16 v[136:139], v[64:67], v[152:155], v[136:139]
    ds_read_b128 v[168:171], v110 offset:39936
    v_mfma_f32_16x16x32_bf16 v[140:143], v[64:67], v[156:159], v[140:143]
    ds_read_b128 v[172:175], v112 offset:7168
    v_mfma_f32_16x16x32_bf16 v[144:147], v[64:67], v[160:163], v[144:147]
    ds_read_b128 v[176:179], v112 offset:39936
    s_waitcnt vmcnt(19) lgkmcnt(4)
    v_mfma_f32_16x16x32_bf16 v[132:135], v[68:71], v[88:91], v[132:135]
    ds_read_b128 v[148:151], v111 offset:7168
    v_mfma_f32_16x16x32_bf16 v[136:139], v[68:71], v[92:95], v[136:139]
    ds_read_b128 v[152:155], v111 offset:39936
    v_mfma_f32_16x16x32_bf16 v[140:143], v[68:71], v[96:99], v[140:143]
    ds_read_b128 v[156:159], v113 offset:7168
    v_mfma_f32_16x16x32_bf16 v[144:147], v[68:71], v[100:103], v[144:147]
    ds_read_b128 v[160:163], v113 offset:39936
    v_cmp_eq_u32 vcc, 0, v15
    s_nop 1
    v_cndmask_b32 v208, v208, 1.0, vcc
    v_cndmask_b32 v209, v209, 0, vcc
    v_cndmask_b32 v210, v210, 1.0, vcc
    v_cndmask_b32 v211, v211, 0, vcc
    v_and_b32 v4, 1, v15
    v_cmp_eq_u32 vcc, 1, v4
    s_nop 1
    v_cndmask_b32 v204, 1.0, v196, vcc
    v_cndmask_b32 v205, 0, v197, vcc
    v_cndmask_b32 v206, 1.0, v198, vcc
    v_cndmask_b32 v207, 0, v199, vcc
    s_cmp_eq_u32 s35, 0
    s_cselect_b64 vcc, -1, 0
    v_cndmask_b32 v212, v212, 1.0, vcc
    v_cndmask_b32 v213, v213, 0, vcc
    v_cndmask_b32 v214, v214, 1.0, vcc
    v_cndmask_b32 v215, v215, 0, vcc
    s_cmp_eq_u32 s36, 0
    s_cselect_b64 vcc, -1, 0
    v_cndmask_b32 v216, v216, 1.0, vcc
    v_cndmask_b32 v217, v217, 0, vcc
    v_cndmask_b32 v218, v218, 1.0, vcc
    v_cndmask_b32 v219, v219, 0, vcc
    s_waitcnt vmcnt(18) lgkmcnt(4)
    v_mfma_f32_16x16x32_bf16 v[132:135], v[72:75], v[164:167], v[132:135]
    v_mfma_f32_16x16x32_bf16 v[136:139], v[72:75], v[168:171], v[136:139]
    v_mfma_f32_16x16x32_bf16 v[140:143], v[72:75], v[172:175], v[140:143]
    v_mfma_f32_16x16x32_bf16 v[144:147], v[72:75], v[176:179], v[144:147]
    v_pk_mul_f32 v[180:181], v[212:213], v[216:217] op_sel_hi:[1,0]
    v_pk_fma_f32 v[180:181], v[212:213], v[216:217], v[180:181] op_sel:[1,1,0] op_sel_hi:[0,1,1] neg_lo:[0,1,0]
    v_pk_mul_f32 v[182:183], v[214:215], v[218:219] op_sel_hi:[1,0]
    v_pk_fma_f32 v[182:183], v[214:215], v[218:219], v[182:183] op_sel:[1,1,0] op_sel_hi:[0,1,1] neg_lo:[0,1,0]
    v_pk_mul_f32 v[184:185], v[180:181], v[208:209] op_sel_hi:[1,0]
    v_pk_fma_f32 v[184:185], v[180:181], v[208:209], v[184:185] op_sel:[1,1,0] op_sel_hi:[0,1,1] neg_lo:[0,1,0]
    v_pk_mul_f32 v[186:187], v[182:183], v[210:211] op_sel_hi:[1,0]
    v_pk_fma_f32 v[186:187], v[182:183], v[210:211], v[186:187] op_sel:[1,1,0] op_sel_hi:[0,1,1] neg_lo:[0,1,0]
    s_waitcnt vmcnt(17) lgkmcnt(0)
    v_mfma_f32_16x16x32_bf16 v[132:135], v[76:79], v[148:151], v[132:135]
    v_mfma_f32_16x16x32_bf16 v[136:139], v[76:79], v[152:155], v[136:139]
    v_mfma_f32_16x16x32_bf16 v[140:143], v[76:79], v[156:159], v[140:143]
    v_mfma_f32_16x16x32_bf16 v[144:147], v[76:79], v[160:163], v[144:147]
    s_waitcnt vmcnt(15)
    s_barrier
    s_and_b32 s48, s3, 31
    s_lshl_b32 s48, s48, 2
    s_add_u32 s48, s48, s101
    s_cmp_eq_u32 s34, 4
    s_cselect_b32 s48, s48, 50331648
    v_mov_b32 v3, 0
    v_mov_b32 v13, s100
    s_mov_b64 exec, 1
    buffer_store_dword v13, v3, s[16:19], s48 offen sc1
    s_mov_b64 exec, -1
    s_add_u32 m0, s52, 6144
    s_mul_i32 s49, s71, 1792
    buffer_load_dwordx4 v234, s[12:15], s49 offen lds
    s_mul_i32 s49, s71, 1792
    s_add_u32 m0, s52, 7168
    s_add_u32 s49, s49, 14336
    buffer_load_dwordx4 v234, s[12:15], s49 offen lds
    v_mul_f32 v164, v193, v140
    v_mul_f32 v165, v193, v132
    v_fma_f32 v164, v192, v132, -v164
    v_fma_f32 v165, v192, v140, v165
    v_mul_f32 v166, v193, v141
    v_mul_f32 v167, v193, v133
    v_fma_f32 v166, v192, v133, -v166
    v_fma_f32 v167, v192, v141, v167
    v_mul_f32 v168, v193, v142
    v_mul_f32 v169, v193, v134
    v_fma_f32 v168, v192, v134, -v168
    v_fma_f32 v169, v192, v142, v169
    v_mul_f32 v170, v193, v143
    v_mul_f32 v171, v193, v135
    v_fma_f32 v170, v192, v135, -v170
    v_fma_f32 v171, v192, v143, v171
    v_mul_f32 v172, v195, v144
    v_mul_f32 v173, v195, v136
    v_fma_f32 v172, v194, v136, -v172
    v_fma_f32 v173, v194, v144, v173
    v_mul_f32 v174, v195, v145
    v_mul_f32 v175, v195, v137
    v_fma_f32 v174, v194, v137, -v174
    v_fma_f32 v175, v194, v145, v175
    v_mul_f32 v176, v195, v146
    v_mul_f32 v177, v195, v138
    v_fma_f32 v176, v194, v138, -v176
    v_fma_f32 v177, v194, v146, v177
    v_mul_f32 v178, v195, v147
    v_mul_f32 v179, v195, v139
    v_fma_f32 v178, v194, v139, -v178
    v_fma_f32 v179, v194, v147, v179
    v_pk_fma_f32 v[166:167], v[164:165], v[188:189], v[166:167] op_sel_hi:[1,0,1]
    v_pk_fma_f32 v[166:167], v[164:165], v[188:189], v[166:167] op_sel:[1,1,0] op_sel_hi:[0,1,1] neg_lo:[0,1,0]
    v_pk_fma_f32 v[174:175], v[172:173], v[190:191], v[174:175] op_sel_hi:[1,0,1]
    v_pk_fma_f32 v[174:175], v[172:173], v[190:191], v[174:175] op_sel:[1,1,0] op_sel_hi:[0,1,1] neg_lo:[0,1,0]
    v_pk_fma_f32 v[168:169], v[166:167], v[188:189], v[168:169] op_sel_hi:[1,0,1]
    v_pk_fma_f32 v[168:169], v[166:167], v[188:189], v[168:169] op_sel:[1,1,0] op_sel_hi:[0,1,1] neg_lo:[0,1,0]
    v_pk_fma_f32 v[176:177], v[174:175], v[190:191], v[176:177] op_sel_hi:[1,0,1]
    v_pk_fma_f32 v[176:177], v[174:175], v[190:191], v[176:177] op_sel:[1,1,0] op_sel_hi:[0,1,1] neg_lo:[0,1,0]
    v_pk_fma_f32 v[170:171], v[168:169], v[188:189], v[170:171] op_sel_hi:[1,0,1]
    v_pk_fma_f32 v[170:171], v[168:169], v[188:189], v[170:171] op_sel:[1,1,0] op_sel_hi:[0,1,1] neg_lo:[0,1,0]
    v_pk_fma_f32 v[178:179], v[176:177], v[190:191], v[178:179] op_sel_hi:[1,0,1]
    v_pk_fma_f32 v[178:179], v[176:177], v[190:191], v[178:179] op_sel:[1,1,0] op_sel_hi:[0,1,1] neg_lo:[0,1,0]
    v_mov_b32 v88, 0
    v_mov_b32 v92, v170
    v_mov_b32 v89, 0
    v_mov_b32 v93, v171
    v_mov_b32 v90, 0
    v_mov_b32 v94, v178
    v_mov_b32 v91, 0
    v_mov_b32 v95, v179
    v_permlane16_swap_b32 v88, v92
    v_permlane16_swap_b32 v89, v93
    v_permlane16_swap_b32 v90, v94
    v_permlane16_swap_b32 v91, v95
    v_pk_fma_f32 v[96:97], v[88:89], v[196:197], v[170:171] op_sel_hi:[1,0,1]
    v_pk_fma_f32 v[96:97], v[88:89], v[196:197], v[96:97] op_sel:[1,1,0] op_sel_hi:[0,1,1] neg_lo:[0,1,0]
    v_pk_fma_f32 v[98:99], v[90:91], v[198:199], v[178:179] op_sel_hi:[1,0,1]
    v_pk_fma_f32 v[98:99], v[90:91], v[198:199], v[98:99] op_sel:[1,1,0] op_sel_hi:[0,1,1] neg_lo:[0,1,0]
    v_mov_b32 v100, v96
    v_mov_b32 v148, 0
    v_mov_b32 v101, v97
    v_mov_b32 v149, 0
    v_mov_b32 v102, v98
    v_mov_b32 v150, 0
    v_mov_b32 v103, v99
    v_mov_b32 v151, 0
    v_permlane16_swap_b32 v100, v96
    v_permlane16_swap_b32 v101, v97
    v_permlane16_swap_b32 v102, v98
    v_permlane16_swap_b32 v103, v99
    v_permlane32_swap_b32 v148, v96
    v_permlane32_swap_b32 v149, v97
    v_permlane32_swap_b32 v150, v98
    v_permlane32_swap_b32 v151, v99
    v_pk_fma_f32 v[180:181], v[148:149], v[204:205], v[88:89] op_sel_hi:[1,0,1]
    v_pk_fma_f32 v[180:181], v[148:149], v[204:205], v[180:181] op_sel:[1,1,0] op_sel_hi:[0,1,1] neg_lo:[0,1,0]
    v_pk_fma_f32 v[182:183], v[150:151], v[206:207], v[90:91] op_sel_hi:[1,0,1]
    v_pk_fma_f32 v[182:183], v[150:151], v[206:207], v[182:183] op_sel:[1,1,0] op_sel_hi:[0,1,1] neg_lo:[0,1,0]
    v_pk_fma_f32 v[204:205], v[180:181], v[196:197], v[170:171] op_sel_hi:[1,0,1]
    v_pk_fma_f32 v[204:205], v[180:181], v[196:197], v[204:205] op_sel:[1,1,0] op_sel_hi:[0,1,1] neg_lo:[0,1,0]
    v_pk_fma_f32 v[206:207], v[182:183], v[198:199], v[178:179] op_sel_hi:[1,0,1]
    v_pk_fma_f32 v[206:207], v[182:183], v[198:199], v[206:207] op_sel:[1,1,0] op_sel_hi:[0,1,1] neg_lo:[0,1,0]
    s_lshl_b32 s48, s34, 8
    s_add_u32 s48, s48, 155136
    v_lshl_add_u32 v4, v14, 4, s48
    s_mov_b32 s48, 0
    s_mov_b32 s49, 0xffff0000
    s_mov_b64 exec, s[48:49]
    ds_write_b128 v4, v[204:207]
    s_mov_b64 exec, -1
    v_subrev_u32 v12, 1792, v4
    s_waitcnt vmcnt(3) lgkmcnt(0)
    s_barrier
    ds_read_b128 v[88:91], v12 offset:0
    ds_read_b128 v[92:95], v12 offset:256
    ds_read_b128 v[96:99], v12 offset:512
    ds_read_b128 v[100:103], v12 offset:768
    ds_read_b128 v[84:87], v12 offset:1024
    ds_read_b128 v[4:7], v12 offset:1280
    ds_read_b128 v[8:11], v12 offset:1536
    s_load_dwordx2 s[88:89], s[0:1], 64
    s_load_dwordx2 s[90:91], s[0:1], 96
    ds_read_b64_tr_b16 v[132:133], v220 offset:8192
    ds_read_b64_tr_b16 v[134:135], v220 offset:9216
    ds_read_b64_tr_b16 v[136:137], v221 offset:8192
    ds_read_b64_tr_b16 v[138:139], v221 offset:9216
    ds_read_b64_tr_b16 v[140:141], v227 offset:8192
    ds_read_b64_tr_b16 v[142:143], v227 offset:9216
    ds_read_b64_tr_b16 v[144:145], v228 offset:8192
    ds_read_b64_tr_b16 v[146:147], v228 offset:9216
    s_waitcnt lgkmcnt(8)
    v_pk_fma_f32 v[92:93], v[88:89], v[200:201], v[92:93] op_sel_hi:[1,0,1]
    v_pk_fma_f32 v[92:93], v[88:89], v[200:201], v[92:93] op_sel:[1,1,0] op_sel_hi:[0,1,1] neg_lo:[0,1,0]
    v_pk_fma_f32 v[94:95], v[90:91], v[202:203], v[94:95] op_sel_hi:[1,0,1]
    v_pk_fma_f32 v[94:95], v[90:91], v[202:203], v[94:95] op_sel:[1,1,0] op_sel_hi:[0,1,1] neg_lo:[0,1,0]
    v_pk_fma_f32 v[96:97], v[92:93], v[200:201], v[96:97] op_sel_hi:[1,0,1]
    v_pk_fma_f32 v[96:97], v[92:93], v[200:201], v[96:97] op_sel:[1,1,0] op_sel_hi:[0,1,1] neg_lo:[0,1,0]
    v_pk_fma_f32 v[98:99], v[94:95], v[202:203], v[98:99] op_sel_hi:[1,0,1]
    v_pk_fma_f32 v[98:99], v[94:95], v[202:203], v[98:99] op_sel:[1,1,0] op_sel_hi:[0,1,1] neg_lo:[0,1,0]
    v_pk_fma_f32 v[100:101], v[96:97], v[200:201], v[100:101] op_sel_hi:[1,0,1]
    v_pk_fma_f32 v[100:101], v[96:97], v[200:201], v[100:101] op_sel:[1,1,0] op_sel_hi:[0,1,1] neg_lo:[0,1,0]
    v_pk_fma_f32 v[102:103], v[98:99], v[202:203], v[102:103] op_sel_hi:[1,0,1]
    v_pk_fma_f32 v[102:103], v[98:99], v[202:203], v[102:103] op_sel:[1,1,0] op_sel_hi:[0,1,1] neg_lo:[0,1,0]
    v_pk_fma_f32 v[84:85], v[100:101], v[200:201], v[84:85] op_sel_hi:[1,0,1]
    v_pk_fma_f32 v[84:85], v[100:101], v[200:201], v[84:85] op_sel:[1,1,0] op_sel_hi:[0,1,1] neg_lo:[0,1,0]
    v_pk_fma_f32 v[86:87], v[102:103], v[202:203], v[86:87] op_sel_hi:[1,0,1]
    v_pk_fma_f32 v[86:87], v[102:103], v[202:203], v[86:87] op_sel:[1,1,0] op_sel_hi:[0,1,1] neg_lo:[0,1,0]
    v_pk_fma_f32 v[4:5], v[84:85], v[200:201], v[4:5] op_sel_hi:[1,0,1]
    v_pk_fma_f32 v[4:5], v[84:85], v[200:201], v[4:5] op_sel:[1,1,0] op_sel_hi:[0,1,1] neg_lo:[0,1,0]
    v_pk_fma_f32 v[6:7], v[86:87], v[202:203], v[6:7] op_sel_hi:[1,0,1]
    v_pk_fma_f32 v[6:7], v[86:87], v[202:203], v[6:7] op_sel:[1,1,0] op_sel_hi:[0,1,1] neg_lo:[0,1,0]
    v_pk_fma_f32 v[8:9], v[4:5], v[200:201], v[8:9] op_sel_hi:[1,0,1]
    v_pk_fma_f32 v[8:9], v[4:5], v[200:201], v[8:9] op_sel:[1,1,0] op_sel_hi:[0,1,1] neg_lo:[0,1,0]
    v_pk_fma_f32 v[10:11], v[6:7], v[202:203], v[10:11] op_sel_hi:[1,0,1]
    v_pk_fma_f32 v[10:11], v[6:7], v[202:203], v[10:11] op_sel:[1,1,0] op_sel_hi:[0,1,1] neg_lo:[0,1,0]
    v_pk_fma_f32 v[204:205], v[8:9], v[200:201], v[204:205] op_sel_hi:[1,0,1]
    v_pk_fma_f32 v[204:205], v[8:9], v[200:201], v[204:205] op_sel:[1,1,0] op_sel_hi:[0,1,1] neg_lo:[0,1,0]
    v_pk_fma_f32 v[206:207], v[10:11], v[202:203], v[206:207] op_sel_hi:[1,0,1]
    v_pk_fma_f32 v[206:207], v[10:11], v[202:203], v[206:207] op_sel:[1,1,0] op_sel_hi:[0,1,1] neg_lo:[0,1,0]
    s_cmp_lg_u32 s34, 7
    s_cbranch_scc1 KF_npub
    v_lshlrev_b32 v3, 4, v14
    v_mov_b32 v88, v204
    v_mov_b32 v89, v205
    v_mov_b32 v90, s100
    v_mov_b32 v91, s100
    v_mov_b32 v92, v206
    v_mov_b32 v93, v207
    v_mov_b32 v94, s100
    v_mov_b32 v95, s100
    s_mov_b32 s48, 0
    s_mov_b32 s49, 0xffff0000
    s_mov_b64 exec, s[48:49]
    buffer_store_dwordx4 v[88:91], v3, s[16:19], s47 offen sc1
    buffer_store_dwordx4 v[92:95], v3, s[16:19], s47 offen offset:256 sc1
    s_mov_b64 exec, -1
    s_branch KF_npub
KF_st1:
    s_branch KF_ret
KF_npub:
    s_nop 7
    s_nop 3
    ds_read_b64_tr_b16 v[148:149], v220 offset:10240
    ds_read_b64_tr_b16 v[150:151], v220 offset:11264
    ds_read_b64_tr_b16 v[152:153], v221 offset:10240
    ds_read_b64_tr_b16 v[154:155], v221 offset:11264
    ds_read_b64_tr_b16 v[156:157], v227 offset:10240
    ds_read_b64_tr_b16 v[158:159], v227 offset:11264
    v_pk_fma_f32 v[180:181], v[8:9], v[208:209], v[180:181] op_sel_hi:[1,0,1]
    v_pk_fma_f32 v[180:181], v[8:9], v[208:209], v[180:181] op_sel:[1,1,0] op_sel_hi:[0,1,1] neg_lo:[0,1,0]
    v_pk_fma_f32 v[182:183], v[10:11], v[210:211], v[182:183] op_sel_hi:[1,0,1]
    v_pk_fma_f32 v[182:183], v[10:11], v[210:211], v[182:183] op_sel:[1,1,0] op_sel_hi:[0,1,1] neg_lo:[0,1,0]
    s_waitcnt lgkmcnt(12)
    v_mfma_f32_16x16x32_bf16 v[104:107], v[132:135], v[16:19], 0
    ds_read_b64_tr_b16 v[160:161], v228 offset:10240
    ds_read_b64_tr_b16 v[162:163], v228 offset:11264
    s_add_u32 s48, s33, s32
    s_lshl_b32 s49, s32, 1
    s_add_u32 s48, s48, s49
    s_and_b32 s62, s48, 7
    s_mul_i32 s48, s62, 11
    s_lshr_b32 s48, s48, 5
    s_mul_i32 s48, s48, 3
    s_waitcnt lgkmcnt(12)
    v_mfma_f32_16x16x32_bf16 v[108:111], v[136:139], v[16:19], 0
    ds_read_b64_tr_b16 v[132:133], v220 offset:12288
    ds_read_b64_tr_b16 v[134:135], v220 offset:13312
    s_sub_u32 s59, s62, s48
    s_and_b32 s60, s33, 3
    s_lshl_b32 s61, s60, 18
    s_lshl_b32 s48, s63, 17
    s_add_u32 s61, s61, s48
    s_add_u32 s61, s61, 23068672
    s_lshl_b32 s58, s63, 14
    s_waitcnt lgkmcnt(12)
    v_mfma_f32_16x16x32_bf16 v[104:107], v[140:143], v[20:23], v[104:107]
    ds_read_b64_tr_b16 v[136:137], v221 offset:12288
    ds_read_b64_tr_b16 v[138:139], v221 offset:13312
    s_add_u32 s48, s62, 0
    s_and_b32 s48, s48, 3
    s_lshl_b32 s40, s48, 12
    s_add_u32 s48, s62, 1
    s_and_b32 s48, s48, 3
    s_lshl_b32 s41, s48, 12
    s_cmp_lg_u32 s34, 5
    s_cbranch_scc1 KF_nsd
    v_and_b32 v244, 31, v2
    v_lshlrev_b32 v244, 2, v244
    buffer_load_dword v245, v244, s[16:19], s101 offen sc1
KF_nsd:
    s_nop 7
    s_nop 3
    s_waitcnt lgkmcnt(12)
    v_mfma_f32_16x16x32_bf16 v[108:111], v[144:147], v[20:23], v[108:111]
    ds_read_b64_tr_b16 v[140:141], v227 offset:12288
    ds_read_b64_tr_b16 v[142:143], v227 offset:13312
    s_add_u32 s48, s62, 2
    s_and_b32 s48, s48, 3
    s_lshl_b32 s42, s48, 12
    s_add_u32 s48, s62, 3
    s_and_b32 s48, s48, 3
    s_lshl_b32 s43, s48, 12
    s_add_u32 s48, s59, 4
    s_waitcnt lgkmcnt(12)
    v_mfma_f32_16x16x32_bf16 v[104:107], v[148:151], v[24:27], v[104:107]
    ds_read_b64_tr_b16 v[144:145], v228 offset:12288
    ds_read_b64_tr_b16 v[146:147], v228 offset:13312
    s_sub_u32 s49, s48, 3
    s_cmp_ge_u32 s48, 7
    s_cselect_b32 s48, s49, s48
    s_lshl_b32 s44, s48, 12
    s_add_u32 s48, s59, 5
    s_sub_u32 s49, s48, 3
    s_waitcnt lgkmcnt(12)
    v_mfma_f32_16x16x32_bf16 v[108:111], v[152:155], v[24:27], v[108:111]
    ds_read_b64_tr_b16 v[148:149], v220 offset:14336
    ds_read_b64_tr_b16 v[150:151], v220 offset:15360
    s_cmp_ge_u32 s48, 7
    s_cselect_b32 s48, s49, s48
    s_lshl_b32 s45, s48, 12
    s_add_u32 s48, s59, 6
    s_sub_u32 s49, s48, 3
    s_cmp_ge_u32 s48, 7
    s_cselect_b32 s48, s49, s48
    s_waitcnt lgkmcnt(12)
    v_mfma_f32_16x16x32_bf16 v[104:107], v[156:159], v[28:31], v[104:107]
    ds_read_b64_tr_b16 v[152:153], v221 offset:14336
    ds_read_b64_tr_b16 v[154:155], v221 offset:15360
    s_lshl_b32 s46, s48, 12
    s_add_u32 s48, s62, 0
    s_and_b32 s48, s48, 7
    s_lshl_b32 s49, s48, 14
    s_add_u32 s72, s49, s61
    s_lshl_b32 s49, s48, 11
    s_waitcnt lgkmcnt(12)
    v_mfma_f32_16x16x32_bf16 v[108:111], v[160:163], v[28:31], v[108:111]
    ds_read_b64_tr_b16 v[156:157], v227 offset:14336
    ds_read_b64_tr_b16 v[158:159], v227 offset:15360
    s_add_u32 s80, s49, s58
    s_add_u32 s48, s62, 1
    s_and_b32 s48, s48, 7
    s_lshl_b32 s49, s48, 14
    s_add_u32 s73, s49, s61
    s_lshl_b32 s49, s48, 11
    s_add_u32 s81, s49, s58
    s_waitcnt lgkmcnt(12)
    v_mfma_f32_16x16x32_bf16 v[104:107], v[132:135], v[32:35], v[104:107]
    ds_read_b64_tr_b16 v[160:161], v228 offset:14336
    ds_read_b64_tr_b16 v[162:163], v228 offset:15360
    s_add_u32 s48, s62, 2
    s_and_b32 s48, s48, 7
    s_lshl_b32 s49, s48, 14
    s_add_u32 s74, s49, s61
    s_lshl_b32 s49, s48, 11
    s_add_u32 s82, s49, s58
    s_waitcnt lgkmcnt(12)
    v_mfma_f32_16x16x32_bf16 v[108:111], v[136:139], v[32:35], v[108:111]
    ds_read_b64_tr_b16 v[132:133], v220 offset:0
    ds_read_b64_tr_b16 v[134:135], v220 offset:1024
    s_add_u32 s48, s62, 3
    s_and_b32 s48, s48, 7
    s_lshl_b32 s49, s48, 14
    s_add_u32 s75, s49, s61
    s_lshl_b32 s49, s48, 11
    s_add_u32 s83, s49, s58
    s_add_u32 s48, s62, 4
    s_waitcnt lgkmcnt(12)
    v_mfma_f32_16x16x32_bf16 v[104:107], v[140:143], v[36:39], v[104:107]
    ds_read_b64_tr_b16 v[136:137], v221 offset:0
    ds_read_b64_tr_b16 v[138:139], v221 offset:1024
    s_and_b32 s48, s48, 7
    s_lshl_b32 s49, s48, 14
    s_add_u32 s76, s49, s61
    s_lshl_b32 s49, s48, 11
    s_add_u32 s84, s49, s58
    s_add_u32 s48, s62, 5
    s_waitcnt lgkmcnt(12)
    v_mfma_f32_16x16x32_bf16 v[108:111], v[144:147], v[36:39], v[108:111]
    ds_read_b64_tr_b16 v[140:141], v227 offset:0
    ds_read_b64_tr_b16 v[142:143], v227 offset:1024
    s_and_b32 s48, s48, 7
    s_lshl_b32 s49, s48, 14
    s_add_u32 s77, s49, s61
    s_lshl_b32 s49, s48, 11
    s_add_u32 s85, s49, s58
    s_add_u32 s48, s62, 6
    s_and_b32 s48, s48, 7
    s_waitcnt lgkmcnt(12)
    v_mfma_f32_16x16x32_bf16 v[104:107], v[148:151], v[40:43], v[104:107]
    ds_read_b64_tr_b16 v[144:145], v228 offset:0
    ds_read_b64_tr_b16 v[146:147], v228 offset:1024
    s_lshl_b32 s49, s48, 14
    s_add_u32 s78, s49, s61
    s_lshl_b32 s49, s48, 11
    s_add_u32 s86, s49, s58
    s_add_u32 s48, s62, 7
    s_and_b32 s48, s48, 7
    s_lshl_b32 s49, s48, 14
    s_waitcnt lgkmcnt(12)
    v_mfma_f32_16x16x32_bf16 v[108:111], v[152:155], v[40:43], v[108:111]
    ds_read_b64_tr_b16 v[148:149], v220 offset:2048
    ds_read_b64_tr_b16 v[150:151], v220 offset:3072
    s_add_u32 s79, s49, s61
    s_lshl_b32 s49, s48, 11
    s_add_u32 s87, s49, s58
    s_lshl_b32 s48, s60, 3
    s_add_u32 s48, s48, s34
    s_mul_i32 s48, s48, 57344
    s_waitcnt lgkmcnt(12)
    v_mfma_f32_16x16x32_bf16 v[104:107], v[156:159], v[44:47], v[104:107]
    ds_read_b64_tr_b16 v[152:153], v221 offset:2048
    ds_read_b64_tr_b16 v[154:155], v221 offset:3072
    s_mul_i32 s60, s63, 28672
    s_add_u32 s48, s48, s60
    s_add_u32 s48, s48, 18874368
    v_add_u32 v238, s48, v1
    v_add_u32 v236, s51, v1
    v_add_u32 v237, 8192, v236
    s_bfe_u32 s48, s33, 0x10002
    s_waitcnt lgkmcnt(12)
    v_mfma_f32_16x16x32_bf16 v[108:111], v[160:163], v[44:47], v[108:111]
    ds_read_b64_tr_b16 v[156:157], v227 offset:2048
    ds_read_b64_tr_b16 v[158:159], v227 offset:3072
    s_lshl_b32 s48, s48, 1
    s_add_u32 s62, s48, s63
    s_lshl_b32 s48, s32, 3
    s_add_u32 s48, s48, s34
    s_lshl_b32 s48, s48, 15
    s_lshl_b32 s49, s33, 11
    s_waitcnt lgkmcnt(12)
    v_mfma_f32_16x16x32_bf16 v[104:107], v[132:135], v[48:51], v[104:107]
    ds_read_b64_tr_b16 v[160:161], v228 offset:2048
    ds_read_b64_tr_b16 v[162:163], v228 offset:3072
    s_add_u32 s57, s48, s49
    s_lshl_b32 s48, s32, 3
    s_add_u32 s48, s48, s34
    s_mul_i32 s48, s48, 57344
    s_add_u32 s48, s48, s60
    s_add_u32 s48, s48, 10485760
    s_and_b32 s49, s33, 7
    s_waitcnt lgkmcnt(12)
    v_mfma_f32_16x16x32_bf16 v[108:111], v[136:139], v[48:51], v[108:111]
    ds_read_b64_tr_b16 v[132:133], v220 offset:4096
    ds_read_b64_tr_b16 v[134:135], v220 offset:5120
    s_lshl_b32 s58, s49, 11
    s_add_u32 s58, s58, s48
    s_lshl_b32 s3, s49, 10
    s_add_u32 s3, s3, s48
    s_add_u32 s3, s3, 16384
    s_lshr_b32 s59, s49, 1
    s_waitcnt lgkmcnt(12)
    v_mfma_f32_16x16x32_bf16 v[104:107], v[140:143], v[52:55], v[104:107]
    ds_read_b64_tr_b16 v[136:137], v221 offset:4096
    ds_read_b64_tr_b16 v[138:139], v221 offset:5120
    s_lshl_b32 s59, s59, 10
    s_add_u32 s59, s59, s48
    s_lshl_b32 s49, s54, 9
    s_add_u32 s59, s59, s49
    s_add_u32 s59, s59, 24576
    s_mov_b32 s53, 0xbfb8aa3b
    s_bfe_u32 s48, s33, 0x10002
    s_waitcnt lgkmcnt(12)
    v_mfma_f32_16x16x32_bf16 v[108:111], v[144:147], v[52:55], v[108:111]
    ds_read_b64_tr_b16 v[140:141], v227 offset:4096
    ds_read_b64_tr_b16 v[142:143], v227 offset:5120
    s_lshl_b32 s48, s48, 2
    s_lshl_b32 s49, s32, 3
    s_add_u32 s48, s48, s49
    s_lshr_b32 s49, s34, 1
    s_add_u32 s48, s48, s49
    s_and_b32 s49, s34, 1
    s_waitcnt lgkmcnt(12)
    v_mfma_f32_16x16x32_bf16 v[104:107], v[148:151], v[56:59], v[104:107]
    ds_read_b64_tr_b16 v[144:145], v228 offset:4096
    ds_read_b64_tr_b16 v[146:147], v228 offset:5120
    s_lshl_b32 s49, s49, 11
    s_lshl_b32 s50, s48, 16
    s_add_u32 s50, s50, s49
    s_lshr_b32 s50, s50, 1
    v_add_u32 v240, s50, v1
    s_mul_i32 s48, s48, 57344
    s_add_u32 s48, s48, s49
    s_waitcnt lgkmcnt(12)
    v_mfma_f32_16x16x32_bf16 v[108:111], v[152:155], v[56:59], v[108:111]
    s_cmp_eq_u32 s34, 7
    s_cbranch_scc1 KF_b21
    s_waitcnt vmcnt(0)
    s_cmp_lg_u32 s34, 5
    s_cbranch_scc1 KF_b21
    s_movk_i32 s61, 16384
KF_sdl:
    s_nop 7
    s_nop 3
    v_subrev_u32 v245, s20, v245
    v_cmp_lt_u32 vcc, s22, v245
    s_cbranch_vccz KF_b21
    s_sub_u32 s61, s61, 1
    s_cbranch_scc1 KF_b21
    s_sleep 1
    buffer_load_dword v245, v244, s[16:19], s101 offen sc1
    s_waitcnt vmcnt(0)
    s_branch KF_sdl
KF_st2:
    s_branch KF_ret
KF_b21:
    s_nop 7
    s_nop 3
    s_waitcnt vmcnt(2)
    s_barrier
    ds_read_b64_tr_b16 v[148:149], v220 offset:6144
    ds_read_b64_tr_b16 v[150:151], v220 offset:7168
    s_add_u32 s48, s48, s60
    s_add_u32 s48, s48, 10485760
    v_add_u32 v241, s48, v1
    s_lshl_b32 s48, s63, 16
    v_add_u32 v243, s48, v1
    v_xor_b32 v242, 65536, v243
    s_waitcnt lgkmcnt(12)
    v_mfma_f32_16x16x32_bf16 v[104:107], v[156:159], v[60:63], v[104:107]
    ds_read_b64_tr_b16 v[152:153], v221 offset:6144
    ds_read_b64_tr_b16 v[154:155], v221 offset:7168
    s_waitcnt lgkmcnt(12)
    v_mfma_f32_16x16x32_bf16 v[108:111], v[160:163], v[60:63], v[108:111]
    ds_read_b64_tr_b16 v[156:157], v227 offset:6144
    ds_read_b64_tr_b16 v[158:159], v227 offset:7168
    buffer_load_dwordx4 v[80:83], v238, s[16:19], s40 offen offset:0
    s_waitcnt lgkmcnt(12)
    v_mfma_f32_16x16x32_bf16 v[104:107], v[132:135], v[64:67], v[104:107]
    ds_read_b64_tr_b16 v[160:161], v228 offset:6144
    ds_read_b64_tr_b16 v[162:163], v228 offset:7168
    s_waitcnt lgkmcnt(12)
    v_mfma_f32_16x16x32_bf16 v[108:111], v[136:139], v[64:67], v[108:111]
    ds_read_b64_tr_b16 v[132:133], v222 offset:8192
    ds_read_b64_tr_b16 v[134:135], v222 offset:9216
    s_waitcnt lgkmcnt(12)
    v_mfma_f32_16x16x32_bf16 v[104:107], v[140:143], v[68:71], v[104:107]
    ds_read_b64_tr_b16 v[136:137], v229 offset:8192
    ds_read_b64_tr_b16 v[138:139], v229 offset:9216
    s_cmp_lt_u32 s34, 6
    s_cbranch_scc1 KF_nel
    s_and_b32 s48, s33, 7
    s_lshl_b32 s48, s48, 8
    s_and_b32 s49, s34, 1
    s_lshl_b32 s47, s49, 3
    s_add_u32 s48, s48, s47
    s_add_u32 s48, s48, 149504
    v_lshl_add_u32 v8, v14, 4, s48
    ds_read_b64 v[4:5], v8
    s_sub_u32 s48, s32, 1
    v_sub_u32 v8, s48, v15
    v_subrev_u32 v9, 0, v8
    v_cmp_le_i32 s[64:65], 0, v9
    v_lshlrev_b32 v9, 9, v9
    v_lshl_add_u32 v9, v14, 4, v9
    v_mov_b32 v10, 50331648
    v_cndmask_b32 v244, v10, v9, s[64:65]
    v_subrev_u32 v9, 4, v8
    v_cmp_le_i32 s[66:67], 0, v9
    v_lshlrev_b32 v9, 9, v9
    v_lshl_add_u32 v9, v14, 4, v9
    v_mov_b32 v10, 50331648
    v_cndmask_b32 v245, v10, v9, s[66:67]
    v_subrev_u32 v9, 8, v8
    v_cmp_le_i32 s[68:69], 0, v9
    v_lshlrev_b32 v9, 9, v9
    v_lshl_add_u32 v9, v14, 4, v9
    v_mov_b32 v10, 50331648
    v_cndmask_b32 v246, v10, v9, s[68:69]
    v_subrev_u32 v9, 12, v8
    v_cmp_le_i32 s[70:71], 0, v9
    v_lshlrev_b32 v9, 9, v9
    v_lshl_add_u32 v9, v14, 4, v9
    v_mov_b32 v10, 50331648
    v_cndmask_b32 v247, v10, v9, s[70:71]
    s_lshl_b32 s47, s33, 13
    s_lshl_b32 s49, s49, 8
    s_add_u32 s47, s47, s49
    s_add_u32 s47, s47, 22020096
    s_waitcnt lgkmcnt(0)
    v_mul_f32 v3, v5, v5
    v_mul_f32 v209, v4, v5
    v_fma_f32 v208, v4, v4, -v3
    v_add_f32 v209, v209, v209
    v_mul_f32 v3, v209, v209
    v_mul_f32 v213, v208, v209
    v_fma_f32 v212, v208, v208, -v3
    v_add_f32 v213, v213, v213
    v_and_b32 v3, 1, v15
    v_cmp_eq_u32 vcc, 1, v3
    s_nop 1
    v_cndmask_b32 v4, 1.0, v4, vcc
    v_cndmask_b32 v5, 0, v5, vcc
    v_cmp_lt_u32 vcc, 1, v15
    s_nop 1
    v_cndmask_b32 v208, 1.0, v208, vcc
    v_cndmask_b32 v209, 0, v209, vcc
    v_pk_mul_f32 v[216:217], v[4:5], v[208:209] op_sel_hi:[1,0]
    v_pk_fma_f32 v[216:217], v[4:5], v[208:209], v[216:217] op_sel:[1,1,0] op_sel_hi:[0,1,1] neg_lo:[0,1,0]
KF_nel:
    s_nop 7
    s_nop 3
    buffer_load_dwordx4 v[84:87], v238, s[16:19], s40 offen offset:1024
    s_waitcnt lgkmcnt(12)
    v_mfma_f32_16x16x32_bf16 v[108:111], v[144:147], v[68:71], v[108:111]
    ds_read_b64_tr_b16 v[140:141], v222 offset:10240
    ds_read_b64_tr_b16 v[142:143], v222 offset:11264
    s_waitcnt lgkmcnt(12)
    v_mfma_f32_16x16x32_bf16 v[104:107], v[148:151], v[72:75], v[104:107]
    ds_read_b64_tr_b16 v[144:145], v229 offset:10240
    ds_read_b64_tr_b16 v[146:147], v229 offset:11264
    s_lshl_b32 s48, s34, 11
    s_add_u32 s48, s48, 131072
    v_lshrrev_b32 v3, 2, v14
    v_xor_b32 v3, v3, v15
    s_waitcnt lgkmcnt(12)
    v_mfma_f32_16x16x32_bf16 v[108:111], v[152:155], v[72:75], v[108:111]
    ds_read_b64_tr_b16 v[148:149], v222 offset:12288
    ds_read_b64_tr_b16 v[150:151], v222 offset:13312
    v_lshlrev_b32 v3, 3, v3
    v_lshl_add_u32 v3, v14, 5, v3
    v_add_u32 v3, s48, v3
    v_bfe_u32 v12, v2, 2, 2
    buffer_load_dwordx4 v[88:91], v238, s[16:19], s40 offen offset:2048
    s_waitcnt lgkmcnt(12)
    v_mfma_f32_16x16x32_bf16 v[104:107], v[156:159], v[76:79], v[104:107]
    ds_read_b64_tr_b16 v[152:153], v229 offset:12288
    ds_read_b64_tr_b16 v[154:155], v229 offset:13312
    v_lshl_add_u32 v12, v15, 3, v12
    v_lshlrev_b32 v13, 1, v15
    v_and_b32 v13, 3, v13
    s_waitcnt lgkmcnt(12)
    v_mfma_f32_16x16x32_bf16 v[108:111], v[160:163], v[76:79], v[108:111]
    ds_read_b64_tr_b16 v[156:157], v222 offset:14336
    ds_read_b64_tr_b16 v[158:159], v222 offset:15360
    v_and_b32 v4, 3, v2
    v_xor_b32 v13, v13, v4
    v_lshlrev_b32 v13, 3, v13
    v_lshl_add_u32 v12, v12, 5, v13
    s_waitcnt lgkmcnt(12)
    v_mfma_f32_16x16x32_bf16 v[112:115], v[132:135], v[16:19], 0
    ds_read_b64_tr_b16 v[160:161], v229 offset:14336
    ds_read_b64_tr_b16 v[162:163], v229 offset:15360
    v_add_u32 v12, s48, v12
    v_add_u32 v13, 128, v12
    v_xor_b32 v13, 8, v13
    v_lshlrev_b32 v4, 4, v14
    buffer_load_dwordx4 v[92:95], v238, s[16:19], s40 offen offset:3072
    s_waitcnt lgkmcnt(12)
    v_mfma_f32_16x16x32_bf16 v[112:115], v[136:139], v[20:23], v[112:115]
    ds_read_b64_tr_b16 v[132:133], v222 offset:0
    ds_read_b64_tr_b16 v[134:135], v222 offset:1024
    v_add_u32 v4, 151808, v4
    v_and_b32 v5, 7, v2
    v_lshlrev_b32 v5, 2, v5
    s_waitcnt lgkmcnt(12)
    v_mfma_f32_16x16x32_bf16 v[112:115], v[140:143], v[24:27], v[112:115]
    ds_read_b64_tr_b16 v[136:137], v229 offset:0
    ds_read_b64_tr_b16 v[138:139], v229 offset:1024
    v_cvt_pk_bf16_f32 v200, v104, v105
    v_cvt_pk_bf16_f32 v201, v106, v107
    v_lshlrev_b32 v104, 16, v200
    v_and_b32 v105, 0xffff0000, v200
    s_waitcnt lgkmcnt(12)
    v_mfma_f32_16x16x32_bf16 v[112:115], v[144:147], v[28:31], v[112:115]
    ds_read_b64_tr_b16 v[140:141], v222 offset:2048
    ds_read_b64_tr_b16 v[142:143], v222 offset:3072
    v_lshlrev_b32 v106, 16, v201
    v_and_b32 v107, 0xffff0000, v201
    v_mul_f32 v204, s53, v104
    buffer_load_dwordx4 v[96:99], v238, s[16:19], s41 offen offset:0
    s_waitcnt lgkmcnt(12)
    v_mfma_f32_16x16x32_bf16 v[112:115], v[148:151], v[32:35], v[112:115]
    ds_read_b64_tr_b16 v[144:145], v229 offset:2048
    ds_read_b64_tr_b16 v[146:147], v229 offset:3072
    v_mul_f32 v205, s53, v105
    v_mul_f32 v206, s53, v106
    v_mul_f32 v207, s53, v107
    v_exp_f32 v204, v204
    s_waitcnt lgkmcnt(12)
    v_mfma_f32_16x16x32_bf16 v[112:115], v[152:155], v[36:39], v[112:115]
    ds_read_b64_tr_b16 v[148:149], v222 offset:4096
    ds_read_b64_tr_b16 v[150:151], v222 offset:5120
    v_exp_f32 v205, v205
    v_exp_f32 v206, v206
    v_exp_f32 v207, v207
    s_waitcnt lgkmcnt(12)
    v_mfma_f32_16x16x32_bf16 v[112:115], v[156:159], v[40:43], v[112:115]
    ds_read_b64_tr_b16 v[152:153], v229 offset:4096
    ds_read_b64_tr_b16 v[154:155], v229 offset:5120
    v_add_f32 v204, 1.0, v204
    v_add_f32 v205, 1.0, v205
    v_add_f32 v206, 1.0, v206
    v_add_f32 v207, 1.0, v207
    buffer_load_dwordx4 v[100:103], v238, s[16:19], s41 offen offset:1024
    s_waitcnt lgkmcnt(12)
    v_mfma_f32_16x16x32_bf16 v[112:115], v[160:163], v[44:47], v[112:115]
    ds_read_b64_tr_b16 v[156:157], v222 offset:6144
    ds_read_b64_tr_b16 v[158:159], v222 offset:7168
    v_rcp_f32 v204, v204
    v_rcp_f32 v205, v205
    v_rcp_f32 v206, v206
    s_waitcnt lgkmcnt(12)
    v_mfma_f32_16x16x32_bf16 v[112:115], v[132:135], v[48:51], v[112:115]
    ds_read_b64_tr_b16 v[160:161], v229 offset:6144
    ds_read_b64_tr_b16 v[162:163], v229 offset:7168
    v_rcp_f32 v207, v207
    v_mul_f32 v104, v104, v204
    v_mul_f32 v105, v105, v205
    v_mul_f32 v106, v106, v206
    s_waitcnt lgkmcnt(12)
    v_mfma_f32_16x16x32_bf16 v[112:115], v[136:139], v[52:55], v[112:115]
    ds_read_b64_tr_b16 v[132:133], v223 offset:8192
    ds_read_b64_tr_b16 v[134:135], v223 offset:9216
    v_mul_f32 v107, v107, v207
    v_cvt_pk_bf16_f32 v192, v104, v105
    v_cvt_pk_bf16_f32 v193, v106, v107
    buffer_load_dwordx4 v[248:251], v238, s[16:19], s41 offen offset:2048
    s_waitcnt lgkmcnt(12)
    v_mfma_f32_16x16x32_bf16 v[112:115], v[140:143], v[56:59], v[112:115]
    ds_read_b64_tr_b16 v[136:137], v230 offset:8192
    ds_read_b64_tr_b16 v[138:139], v230 offset:9216
    v_cvt_pk_bf16_f32 v202, v108, v109
    v_cvt_pk_bf16_f32 v203, v110, v111
    v_lshlrev_b32 v108, 16, v202
    v_and_b32 v109, 0xffff0000, v202
    s_waitcnt lgkmcnt(12)
    v_mfma_f32_16x16x32_bf16 v[112:115], v[144:147], v[60:63], v[112:115]
    ds_read_b64_tr_b16 v[140:141], v223 offset:10240
    ds_read_b64_tr_b16 v[142:143], v223 offset:11264
    v_lshlrev_b32 v110, 16, v203
    v_and_b32 v111, 0xffff0000, v203
    v_mul_f32 v204, s53, v108
    s_waitcnt lgkmcnt(12)
    v_mfma_f32_16x16x32_bf16 v[112:115], v[148:151], v[64:67], v[112:115]
    ds_read_b64_tr_b16 v[144:145], v230 offset:10240
    ds_read_b64_tr_b16 v[146:147], v230 offset:11264
    v_mul_f32 v205, s53, v109
    v_mul_f32 v206, s53, v110
    v_mul_f32 v207, s53, v111
    v_exp_f32 v204, v204
    s_waitcnt lgkmcnt(12)
    v_mfma_f32_16x16x32_bf16 v[112:115], v[152:155], v[68:71], v[112:115]
    ds_read_b64_tr_b16 v[148:149], v223 offset:12288
    ds_read_b64_tr_b16 v[150:151], v223 offset:13312
    v_exp_f32 v205, v205
    v_exp_f32 v206, v206
    v_exp_f32 v207, v207
    s_waitcnt lgkmcnt(12)
    v_mfma_f32_16x16x32_bf16 v[112:115], v[156:159], v[72:75], v[112:115]
    ds_read_b64_tr_b16 v[152:153], v230 offset:12288
    ds_read_b64_tr_b16 v[154:155], v230 offset:13312
    v_add_f32 v204, 1.0, v204
    v_add_f32 v205, 1.0, v205
    v_add_f32 v206, 1.0, v206
    v_add_f32 v207, 1.0, v207
    s_waitcnt lgkmcnt(12)
    v_mfma_f32_16x16x32_bf16 v[112:115], v[160:163], v[76:79], v[112:115]
    ds_read_b64_tr_b16 v[156:157], v223 offset:14336
    ds_read_b64_tr_b16 v[158:159], v223 offset:15360
    v_rcp_f32 v204, v204
    v_rcp_f32 v205, v205
    v_rcp_f32 v206, v206
    s_waitcnt lgkmcnt(12)
    v_mfma_f32_16x16x32_bf16 v[116:119], v[132:135], v[16:19], 0
    ds_read_b64_tr_b16 v[160:161], v230 offset:14336
    ds_read_b64_tr_b16 v[162:163], v230 offset:15360
    v_rcp_f32 v207, v207
    v_mul_f32 v108, v108, v204
    v_mul_f32 v109, v109, v205
    v_mul_f32 v110, v110, v206
    s_waitcnt lgkmcnt(12)
    v_mfma_f32_16x16x32_bf16 v[116:119], v[136:139], v[20:23], v[116:119]
    ds_read_b64_tr_b16 v[132:133], v223 offset:0
    ds_read_b64_tr_b16 v[134:135], v223 offset:1024
    v_mul_f32 v111, v111, v207
    v_cvt_pk_bf16_f32 v194, v108, v109
    v_cvt_pk_bf16_f32 v195, v110, v111
    buffer_store_dwordx4 v[192:195], v1, s[16:19], s58 offen offset:0 sc1
    s_waitcnt lgkmcnt(12)
    v_mfma_f32_16x16x32_bf16 v[116:119], v[140:143], v[24:27], v[116:119]
    ds_read_b64_tr_b16 v[136:137], v230 offset:0
    ds_read_b64_tr_b16 v[138:139], v230 offset:1024
    v_cvt_pk_bf16_f32 v200, v112, v113
    v_cvt_pk_bf16_f32 v201, v114, v115
    v_lshlrev_b32 v112, 16, v200
    v_and_b32 v113, 0xffff0000, v200
    s_cmp_lt_u32 s34, 6
    s_cbranch_scc1 KF_nel2
    buffer_load_dwordx4 v[104:107], v244, s[16:19], s47 offen sc1
    buffer_load_dwordx4 v[108:111], v245, s[16:19], s47 offen sc1
    buffer_load_dwordx4 v[8:11], v246, s[16:19], s47 offen sc1
    buffer_load_dwordx4 v[208:211], v247, s[16:19], s47 offen sc1
KF_nel2:
    s_nop 7
    s_nop 3
    s_waitcnt lgkmcnt(12)
    v_mfma_f32_16x16x32_bf16 v[116:119], v[144:147], v[28:31], v[116:119]
    ds_read_b64_tr_b16 v[140:141], v223 offset:2048
    ds_read_b64_tr_b16 v[142:143], v223 offset:3072
    v_lshlrev_b32 v114, 16, v201
    v_and_b32 v115, 0xffff0000, v201
    v_mul_f32 v204, s53, v112
    s_waitcnt lgkmcnt(12)
    v_mfma_f32_16x16x32_bf16 v[116:119], v[148:151], v[32:35], v[116:119]
    ds_read_b64_tr_b16 v[144:145], v230 offset:2048
    ds_read_b64_tr_b16 v[146:147], v230 offset:3072
    v_mul_f32 v205, s53, v113
    v_mul_f32 v206, s53, v114
    v_mul_f32 v207, s53, v115
    v_exp_f32 v204, v204
    s_waitcnt lgkmcnt(12)
    v_mfma_f32_16x16x32_bf16 v[116:119], v[152:155], v[36:39], v[116:119]
    ds_read_b64_tr_b16 v[148:149], v223 offset:4096
    ds_read_b64_tr_b16 v[150:151], v223 offset:5120
    v_exp_f32 v205, v205
    v_exp_f32 v206, v206
    v_exp_f32 v207, v207
    s_waitcnt lgkmcnt(12)
    v_mfma_f32_16x16x32_bf16 v[116:119], v[156:159], v[40:43], v[116:119]
    ds_read_b64_tr_b16 v[152:153], v230 offset:4096
    ds_read_b64_tr_b16 v[154:155], v230 offset:5120
    v_add_f32 v204, 1.0, v204
    v_add_f32 v205, 1.0, v205
    v_add_f32 v206, 1.0, v206
    v_add_f32 v207, 1.0, v207
    s_waitcnt lgkmcnt(12)
    v_mfma_f32_16x16x32_bf16 v[116:119], v[160:163], v[44:47], v[116:119]
    ds_read_b64_tr_b16 v[156:157], v223 offset:6144
    ds_read_b64_tr_b16 v[158:159], v223 offset:7168
    v_rcp_f32 v204, v204
    v_rcp_f32 v205, v205
    v_rcp_f32 v206, v206
    s_waitcnt lgkmcnt(12)
    v_mfma_f32_16x16x32_bf16 v[116:119], v[132:135], v[48:51], v[116:119]
    ds_read_b64_tr_b16 v[160:161], v230 offset:6144
    ds_read_b64_tr_b16 v[162:163], v230 offset:7168
    v_rcp_f32 v207, v207
    v_mul_f32 v112, v112, v204
    v_mul_f32 v113, v113, v205
    v_mul_f32 v114, v114, v206
    s_waitcnt lgkmcnt(12)
    v_mfma_f32_16x16x32_bf16 v[116:119], v[136:139], v[52:55], v[116:119]
    ds_read_b64_tr_b16 v[132:133], v224 offset:8192
    ds_read_b64_tr_b16 v[134:135], v224 offset:9216
    v_mul_f32 v115, v115, v207
    v_cvt_pk_bf16_f32 v196, v112, v113
    v_cvt_pk_bf16_f32 v197, v114, v115
    s_waitcnt lgkmcnt(12)
    v_mfma_f32_16x16x32_bf16 v[116:119], v[140:143], v[56:59], v[116:119]
    ds_read_b64_tr_b16 v[136:137], v225 offset:8192
    ds_read_b64_tr_b16 v[138:139], v225 offset:9216
    s_waitcnt lgkmcnt(12)
    v_mfma_f32_16x16x32_bf16 v[116:119], v[144:147], v[60:63], v[116:119]
    ds_read_b64_tr_b16 v[140:141], v226 offset:8192
    ds_read_b64_tr_b16 v[142:143], v226 offset:9216
    s_waitcnt lgkmcnt(12)
    v_mfma_f32_16x16x32_bf16 v[116:119], v[148:151], v[64:67], v[116:119]
    ds_read_b64_tr_b16 v[144:145], v231 offset:8192
    ds_read_b64_tr_b16 v[146:147], v231 offset:9216
    s_waitcnt lgkmcnt(12)
    v_mfma_f32_16x16x32_bf16 v[116:119], v[152:155], v[68:71], v[116:119]
    ds_read_b64_tr_b16 v[148:149], v232 offset:8192
    ds_read_b64_tr_b16 v[150:151], v232 offset:9216
    s_waitcnt lgkmcnt(12)
    v_mfma_f32_16x16x32_bf16 v[116:119], v[156:159], v[72:75], v[116:119]
    ds_read_b64_tr_b16 v[152:153], v233 offset:8192
    ds_read_b64_tr_b16 v[154:155], v233 offset:9216
    s_waitcnt lgkmcnt(12)
    v_mfma_f32_16x16x32_bf16 v[116:119], v[160:163], v[76:79], v[116:119]
    ds_read_b64_tr_b16 v[156:157], v224 offset:10240
    ds_read_b64_tr_b16 v[158:159], v224 offset:11264
    s_waitcnt lgkmcnt(12)
    v_mfma_f32_16x16x32_bf16 v[120:123], v[132:135], v[16:19], 0
    ds_read_b64_tr_b16 v[160:161], v225 offset:10240
    ds_read_b64_tr_b16 v[162:163], v225 offset:11264
    s_waitcnt lgkmcnt(12)
    v_mfma_f32_16x16x32_bf16 v[124:127], v[136:139], v[16:19], 0
    ds_read_b64_tr_b16 v[132:133], v226 offset:10240
    ds_read_b64_tr_b16 v[134:135], v226 offset:11264
    s_waitcnt lgkmcnt(12)
    v_mfma_f32_16x16x32_bf16 v[128:131], v[140:143], v[16:19], 0
    ds_read_b64_tr_b16 v[136:137], v231 offset:10240
    ds_read_b64_tr_b16 v[138:139], v231 offset:11264
    v_cvt_pk_bf16_f32 v202, v116, v117
    v_cvt_pk_bf16_f32 v203, v118, v119
    v_lshlrev_b32 v116, 16, v202
    v_and_b32 v117, 0xffff0000, v202
    buffer_load_dwordx4 v[16:19], v238, s[16:19], s43 offen offset:2048
    s_waitcnt lgkmcnt(12)
    v_mfma_f32_16x16x32_bf16 v[120:123], v[144:147], v[20:23], v[120:123]
    ds_read_b64_tr_b16 v[140:141], v232 offset:10240
    ds_read_b64_tr_b16 v[142:143], v232 offset:11264
    v_lshlrev_b32 v118, 16, v203
    v_and_b32 v119, 0xffff0000, v203
    v_mul_f32 v204, s53, v116
    s_waitcnt lgkmcnt(12)
    v_mfma_f32_16x16x32_bf16 v[124:127], v[148:151], v[20:23], v[124:127]
    ds_read_b64_tr_b16 v[144:145], v233 offset:10240
    ds_read_b64_tr_b16 v[146:147], v233 offset:11264
    v_mul_f32 v205, s53, v117
    v_mul_f32 v206, s53, v118
    v_mul_f32 v207, s53, v119
    v_exp_f32 v204, v204
    s_waitcnt lgkmcnt(12)
    v_mfma_f32_16x16x32_bf16 v[128:131], v[152:155], v[20:23], v[128:131]
    ds_read_b64_tr_b16 v[148:149], v224 offset:12288
    ds_read_b64_tr_b16 v[150:151], v224 offset:13312
    v_exp_f32 v205, v205
    v_exp_f32 v206, v206
    v_exp_f32 v207, v207
    buffer_load_dwordx4 v[20:23], v238, s[16:19], s43 offen offset:3072
    s_waitcnt lgkmcnt(12)
    v_mfma_f32_16x16x32_bf16 v[120:123], v[156:159], v[24:27], v[120:123]
    ds_read_b64_tr_b16 v[152:153], v225 offset:12288
    ds_read_b64_tr_b16 v[154:155], v225 offset:13312
    v_add_f32 v204, 1.0, v204
    v_add_f32 v205, 1.0, v205
    v_add_f32 v206, 1.0, v206
    v_add_f32 v207, 1.0, v207
    s_waitcnt lgkmcnt(12)
    v_mfma_f32_16x16x32_bf16 v[124:127], v[160:163], v[24:27], v[124:127]
    ds_read_b64_tr_b16 v[156:157], v226 offset:12288
    ds_read_b64_tr_b16 v[158:159], v226 offset:13312
    v_rcp_f32 v204, v204
    v_rcp_f32 v205, v205
    v_rcp_f32 v206, v206
    s_waitcnt lgkmcnt(12)
    v_mfma_f32_16x16x32_bf16 v[128:131], v[132:135], v[24:27], v[128:131]
    ds_read_b64_tr_b16 v[160:161], v231 offset:12288
    ds_read_b64_tr_b16 v[162:163], v231 offset:13312
    v_rcp_f32 v207, v207
    v_mul_f32 v116, v116, v204
    v_mul_f32 v117, v117, v205
    v_mul_f32 v118, v118, v206
    buffer_load_dwordx4 v[24:27], v238, s[16:19], s44 offen offset:0
    s_waitcnt lgkmcnt(12)
    v_mfma_f32_16x16x32_bf16 v[120:123], v[136:139], v[28:31], v[120:123]
    ds_read_b64_tr_b16 v[132:133], v232 offset:12288
    ds_read_b64_tr_b16 v[134:135], v232 offset:13312
    v_mul_f32 v119, v119, v207
    v_cvt_pk_bf16_f32 v198, v116, v117
    v_cvt_pk_bf16_f32 v199, v118, v119
    buffer_store_dwordx4 v[196:199], v1, s[16:19], s58 offen offset:1024 sc1
    s_waitcnt lgkmcnt(12)
    v_mfma_f32_16x16x32_bf16 v[124:127], v[140:143], v[28:31], v[124:127]
    ds_read_b64_tr_b16 v[136:137], v233 offset:12288
    ds_read_b64_tr_b16 v[138:139], v233 offset:13312
    s_cmp_lt_u32 s34, 6
    s_cbranch_scc1 KF_w7b
    s_movk_i32 s61, 16384
    s_waitcnt vmcnt(4)
KF_hol:
    s_nop 7
    s_nop 3
    v_subrev_u32 v107, s20, v106
    v_cmp_lt_u32 vcc, s22, v107
    s_nop 1
    s_and_b64 s[48:49], vcc, s[64:65]
    v_subrev_u32 v111, s20, v110
    v_cmp_lt_u32 vcc, s22, v111
    s_nop 1
    s_and_b64 vcc, vcc, s[66:67]
    s_or_b64 s[48:49], s[48:49], vcc
    v_subrev_u32 v11, s20, v10
    v_cmp_lt_u32 vcc, s22, v11
    s_nop 1
    s_and_b64 vcc, vcc, s[68:69]
    s_or_b64 s[48:49], s[48:49], vcc
    v_subrev_u32 v211, s20, v210
    v_cmp_lt_u32 vcc, s22, v211
    s_nop 1
    s_and_b64 vcc, vcc, s[70:71]
    s_or_b64 s[48:49], s[48:49], vcc
    s_cbranch_scc0 KF_hod
    s_sub_u32 s61, s61, 1
    s_cbranch_scc1 KF_hod
    s_sleep 1
    buffer_load_dwordx4 v[104:107], v244, s[16:19], s47 offen sc1
    buffer_load_dwordx4 v[108:111], v245, s[16:19], s47 offen sc1
    buffer_load_dwordx4 v[8:11], v246, s[16:19], s47 offen sc1
    buffer_load_dwordx4 v[208:211], v247, s[16:19], s47 offen sc1
    s_waitcnt vmcnt(0)
    s_branch KF_hol
KF_st3:
    s_branch KF_ret
KF_hod:
    s_nop 7
    s_nop 3
    v_pk_fma_f32 v[8:9], v[208:209], v[212:213], v[8:9] op_sel_hi:[1,0,1]
    v_pk_fma_f32 v[8:9], v[208:209], v[212:213], v[8:9] op_sel:[1,1,0] op_sel_hi:[0,1,1] neg_lo:[0,1,0]
    v_pk_fma_f32 v[108:109], v[8:9], v[212:213], v[108:109] op_sel_hi:[1,0,1]
    v_pk_fma_f32 v[108:109], v[8:9], v[212:213], v[108:109] op_sel:[1,1,0] op_sel_hi:[0,1,1] neg_lo:[0,1,0]
    v_pk_fma_f32 v[104:105], v[108:109], v[212:213], v[104:105] op_sel_hi:[1,0,1]
    v_pk_fma_f32 v[104:105], v[108:109], v[212:213], v[104:105] op_sel:[1,1,0] op_sel_hi:[0,1,1] neg_lo:[0,1,0]
    v_pk_mul_f32 v[108:109], v[104:105], v[216:217] op_sel_hi:[1,0]
    v_pk_fma_f32 v[108:109], v[104:105], v[216:217], v[108:109] op_sel:[1,1,0] op_sel_hi:[0,1,1] neg_lo:[0,1,0]
    v_mov_b32 v110, v108
    v_mov_b32 v111, v109
    s_nop 0
    v_permlane16_swap_b32 v108, v110
    v_permlane16_swap_b32 v109, v111
    v_add_f32 v108, v108, v110
    v_add_f32 v109, v109, v111
    v_mov_b32 v110, v108
    v_mov_b32 v111, v109
    s_nop 0
    v_permlane32_swap_b32 v108, v110
    v_permlane32_swap_b32 v109, v111
    v_add_f32 v108, v108, v110
    v_add_f32 v109, v109, v111
    s_and_b32 s48, s34, 1
    s_lshl_b32 s48, s48, 3
    v_add_u32 v8, s48, v4
    s_mov_b64 exec, 0xffff
    ds_write_b64 v8, v[108:109]
    s_mov_b64 exec, -1
    s_waitcnt lgkmcnt(0)
KF_w7b:
    s_nop 7
    s_nop 3
    s_barrier
    ds_read_b128 v[208:211], v4
    s_waitcnt lgkmcnt(13)
    v_mfma_f32_16x16x32_bf16 v[128:131], v[144:147], v[28:31], v[128:131]
    ds_read_b64_tr_b16 v[140:141], v224 offset:14336
    ds_read_b64_tr_b16 v[142:143], v224 offset:15360
    buffer_load_dwordx4 v[28:31], v238, s[16:19], s44 offen offset:1024
    s_waitcnt lgkmcnt(13)
    v_mfma_f32_16x16x32_bf16 v[120:123], v[148:151], v[32:35], v[120:123]
    ds_read_b64_tr_b16 v[144:145], v225 offset:14336
    ds_read_b64_tr_b16 v[146:147], v225 offset:15360
    s_waitcnt lgkmcnt(13)
    v_mfma_f32_16x16x32_bf16 v[124:127], v[152:155], v[32:35], v[124:127]
    ds_read_b64_tr_b16 v[148:149], v226 offset:14336
    ds_read_b64_tr_b16 v[150:151], v226 offset:15360
    s_waitcnt lgkmcnt(6)
    v_pk_fma_f32 v[104:105], v[208:209], v[184:185], v[180:181] op_sel_hi:[1,0,1]
    v_pk_fma_f32 v[104:105], v[208:209], v[184:185], v[104:105] op_sel:[1,1,0] op_sel_hi:[0,1,1] neg_lo:[0,1,0]
    v_pk_fma_f32 v[106:107], v[210:211], v[186:187], v[182:183] op_sel_hi:[1,0,1]
    s_waitcnt lgkmcnt(13)
    v_mfma_f32_16x16x32_bf16 v[128:131], v[156:159], v[32:35], v[128:131]
    ds_read_b64_tr_b16 v[152:153], v231 offset:14336
    ds_read_b64_tr_b16 v[154:155], v231 offset:15360
    v_pk_fma_f32 v[106:107], v[210:211], v[186:187], v[106:107] op_sel:[1,1,0] op_sel_hi:[0,1,1] neg_lo:[0,1,0]
    v_pk_mul_f32 v[108:109], v[104:105], v[188:189] op_sel_hi:[1,0]
    buffer_load_dwordx4 v[32:35], v238, s[16:19], s44 offen offset:2048
    s_waitcnt lgkmcnt(13)
    v_mfma_f32_16x16x32_bf16 v[120:123], v[160:163], v[36:39], v[120:123]
    ds_read_b64_tr_b16 v[156:157], v232 offset:14336
    ds_read_b64_tr_b16 v[158:159], v232 offset:15360
    v_pk_fma_f32 v[108:109], v[104:105], v[188:189], v[108:109] op_sel:[1,1,0] op_sel_hi:[0,1,1] neg_lo:[0,1,0]
    v_pk_add_f32 v[164:165], v[164:165], v[108:109]
    v_pk_mul_f32 v[110:111], v[106:107], v[190:191] op_sel_hi:[1,0]
    s_waitcnt lgkmcnt(13)
    v_mfma_f32_16x16x32_bf16 v[124:127], v[132:135], v[36:39], v[124:127]
    ds_read_b64_tr_b16 v[160:161], v233 offset:14336
    ds_read_b64_tr_b16 v[162:163], v233 offset:15360
    v_pk_fma_f32 v[110:111], v[106:107], v[190:191], v[110:111] op_sel:[1,1,0] op_sel_hi:[0,1,1] neg_lo:[0,1,0]
    v_pk_add_f32 v[172:173], v[172:173], v[110:111]
    s_waitcnt lgkmcnt(13)
    v_mfma_f32_16x16x32_bf16 v[128:131], v[136:139], v[36:39], v[128:131]
    ds_read_b64_tr_b16 v[132:133], v224 offset:0
    ds_read_b64_tr_b16 v[134:135], v224 offset:1024
    v_pk_mul_f32 v[104:105], v[108:109], v[188:189] op_sel_hi:[1,0]
    v_pk_fma_f32 v[104:105], v[108:109], v[188:189], v[104:105] op_sel:[1,1,0] op_sel_hi:[0,1,1] neg_lo:[0,1,0]
    v_pk_add_f32 v[166:167], v[166:167], v[104:105]
    buffer_load_dwordx4 v[36:39], v238, s[16:19], s44 offen offset:3072
    s_waitcnt lgkmcnt(12)
    v_mfma_f32_16x16x32_bf16 v[120:123], v[140:143], v[40:43], v[120:123]
    ds_read_b64_tr_b16 v[136:137], v225 offset:0
    ds_read_b64_tr_b16 v[138:139], v225 offset:1024
    v_pk_mul_f32 v[106:107], v[110:111], v[190:191] op_sel_hi:[1,0]
    v_pk_fma_f32 v[106:107], v[110:111], v[190:191], v[106:107] op_sel:[1,1,0] op_sel_hi:[0,1,1] neg_lo:[0,1,0]
    s_waitcnt lgkmcnt(12)
    v_mfma_f32_16x16x32_bf16 v[124:127], v[144:147], v[40:43], v[124:127]
    ds_read_b64_tr_b16 v[140:141], v226 offset:0
    ds_read_b64_tr_b16 v[142:143], v226 offset:1024
    v_pk_add_f32 v[174:175], v[174:175], v[106:107]
    v_pk_mul_f32 v[108:109], v[104:105], v[188:189] op_sel_hi:[1,0]
    v_pk_fma_f32 v[108:109], v[104:105], v[188:189], v[108:109] op_sel:[1,1,0] op_sel_hi:[0,1,1] neg_lo:[0,1,0]
    s_waitcnt lgkmcnt(12)
    v_mfma_f32_16x16x32_bf16 v[128:131], v[148:151], v[40:43], v[128:131]
    ds_read_b64_tr_b16 v[144:145], v231 offset:0
    ds_read_b64_tr_b16 v[146:147], v231 offset:1024
    v_pk_add_f32 v[168:169], v[168:169], v[108:109]
    v_pk_mul_f32 v[110:111], v[106:107], v[190:191] op_sel_hi:[1,0]
    buffer_load_dwordx4 v[40:43], v238, s[16:19], s45 offen offset:0
    s_waitcnt lgkmcnt(12)
    v_mfma_f32_16x16x32_bf16 v[120:123], v[152:155], v[44:47], v[120:123]
    ds_read_b64_tr_b16 v[148:149], v232 offset:0
    ds_read_b64_tr_b16 v[150:151], v232 offset:1024
    v_pk_fma_f32 v[110:111], v[106:107], v[190:191], v[110:111] op_sel:[1,1,0] op_sel_hi:[0,1,1] neg_lo:[0,1,0]
    v_pk_add_f32 v[176:177], v[176:177], v[110:111]
    s_waitcnt lgkmcnt(12)
    v_mfma_f32_16x16x32_bf16 v[124:127], v[156:159], v[44:47], v[124:127]
    ds_read_b64_tr_b16 v[152:153], v233 offset:0
    ds_read_b64_tr_b16 v[154:155], v233 offset:1024
    v_pk_mul_f32 v[104:105], v[108:109], v[188:189] op_sel_hi:[1,0]
    v_pk_fma_f32 v[104:105], v[108:109], v[188:189], v[104:105] op_sel:[1,1,0] op_sel_hi:[0,1,1] neg_lo:[0,1,0]
    v_pk_add_f32 v[170:171], v[170:171], v[104:105]
    s_waitcnt lgkmcnt(12)
    v_mfma_f32_16x16x32_bf16 v[128:131], v[160:163], v[44:47], v[128:131]
    ds_read_b64_tr_b16 v[156:157], v224 offset:2048
    ds_read_b64_tr_b16 v[158:159], v224 offset:3072
    v_pk_mul_f32 v[106:107], v[110:111], v[190:191] op_sel_hi:[1,0]
    v_pk_fma_f32 v[106:107], v[110:111], v[190:191], v[106:107] op_sel:[1,1,0] op_sel_hi:[0,1,1] neg_lo:[0,1,0]
    buffer_load_dwordx4 v[44:47], v238, s[16:19], s45 offen offset:1024
    s_waitcnt lgkmcnt(12)
    v_mfma_f32_16x16x32_bf16 v[120:123], v[132:135], v[48:51], v[120:123]
    ds_read_b64_tr_b16 v[160:161], v225 offset:2048
    ds_read_b64_tr_b16 v[162:163], v225 offset:3072
    v_pk_add_f32 v[178:179], v[178:179], v[106:107]
    v_cvt_pk_f16_f32 v112, v164, v166
    v_cvt_pk_f16_f32 v113, v168, v170
    s_waitcnt vmcnt(5)
    v_mov_b32 v8, 151568
    v_mov_b32 v9, 1
    s_mov_b64 exec, 1
    ds_add_rtn_u32 v10, v8, v9
    s_mov_b64 exec, -1
    s_waitcnt lgkmcnt(13)
    v_mfma_f32_16x16x32_bf16 v[124:127], v[136:139], v[48:51], v[124:127]
    ds_read_b64_tr_b16 v[132:133], v226 offset:2048
    ds_read_b64_tr_b16 v[134:135], v226 offset:3072
    ds_write_b64 v3, v[112:113] offset:0
    v_cvt_pk_f16_f32 v114, v172, v174
    s_waitcnt lgkmcnt(14)
    v_mfma_f32_16x16x32_bf16 v[128:131], v[140:143], v[48:51], v[128:131]
    ds_read_b64_tr_b16 v[136:137], v231 offset:2048
    ds_read_b64_tr_b16 v[138:139], v231 offset:3072
    v_cvt_pk_f16_f32 v115, v176, v178
    ds_write_b64 v3, v[114:115] offset:512
    v_cvt_pk_f16_f32 v116, -v165, -v167
    buffer_load_dwordx4 v[48:51], v238, s[16:19], s45 offen offset:2048
    s_waitcnt lgkmcnt(15)
    v_mfma_f32_16x16x32_bf16 v[120:123], v[144:147], v[52:55], v[120:123]
    ds_read_b64_tr_b16 v[140:141], v232 offset:2048
    ds_read_b64_tr_b16 v[142:143], v232 offset:3072
    v_cvt_pk_f16_f32 v117, -v169, -v171
    ds_write_b64 v3, v[116:117] offset:1024
    s_waitcnt lgkmcnt(15)
    v_mfma_f32_16x16x32_bf16 v[124:127], v[148:151], v[52:55], v[124:127]
    ds_read_b64_tr_b16 v[144:145], v233 offset:2048
    ds_read_b64_tr_b16 v[146:147], v233 offset:3072
    v_cvt_pk_f16_f32 v118, -v173, -v175
    v_cvt_pk_f16_f32 v119, -v177, -v179
    ds_write_b64 v3, v[118:119] offset:1536
    s_waitcnt lgkmcnt(12)
    v_readfirstlane_b32 s48, v10
    s_nop 1
    s_cmp_lg_u32 s48, 7
    s_cbranch_scc1 KF_nfa
    v_mov_b32 v9, s100
    v_mov_b32 v8, 0
    s_mov_b64 exec, 1
    buffer_store_dword v9, v8, s[16:19], s37 offen offset:0
    buffer_store_dword v9, v8, s[16:19], s37 offen offset:128 sc1
    s_mov_b64 exec, -1
KF_nfa:
    s_nop 7
    s_nop 3
    s_waitcnt lgkmcnt(15)
    v_mfma_f32_16x16x32_bf16 v[128:131], v[152:155], v[52:55], v[128:131]
    ds_read_b64_tr_b16 v[148:149], v224 offset:4096
    ds_read_b64_tr_b16 v[150:151], v224 offset:5120
    ds_read_b64_tr_b16 v[212:213], v12 offset:0
    ds_read_b64_tr_b16 v[214:215], v13 offset:0
    buffer_load_dwordx4 v[52:55], v238, s[16:19], s45 offen offset:3072
    s_waitcnt lgkmcnt(15)
    v_mfma_f32_16x16x32_bf16 v[120:123], v[156:159], v[56:59], v[120:123]
    ds_read_b64_tr_b16 v[152:153], v225 offset:4096
    ds_read_b64_tr_b16 v[154:155], v225 offset:5120
    ds_read_b64_tr_b16 v[216:217], v12 offset:1024
    ds_read_b64_tr_b16 v[218:219], v13 offset:1024
    s_waitcnt lgkmcnt(15)
    v_mfma_f32_16x16x32_bf16 v[124:127], v[160:163], v[56:59], v[124:127]
    ds_read_b64_tr_b16 v[156:157], v226 offset:4096
    ds_read_b64_tr_b16 v[158:159], v226 offset:5120
    s_waitcnt lgkmcnt(15)
    v_mfma_f32_16x16x32_bf16 v[128:131], v[132:135], v[56:59], v[128:131]
    ds_read_b64_tr_b16 v[160:161], v231 offset:4096
    ds_read_b64_tr_b16 v[162:163], v231 offset:5120
    buffer_load_dwordx4 v[56:59], v238, s[16:19], s46 offen offset:0
    s_waitcnt lgkmcnt(15)
    v_mfma_f32_16x16x32_bf16 v[120:123], v[136:139], v[60:63], v[120:123]
    ds_read_b64_tr_b16 v[132:133], v232 offset:4096
    ds_read_b64_tr_b16 v[134:135], v232 offset:5120
    s_waitcnt lgkmcnt(6)
    buffer_store_dwordx4 v[212:215], v1, s[16:19], s57 offen offset:0 sc1
    buffer_store_dwordx4 v[216:219], v1, s[16:19], s57 offen offset:1024 sc1
    s_waitcnt lgkmcnt(15)
    v_mfma_f32_16x16x32_bf16 v[124:127], v[140:143], v[60:63], v[124:127]
    ds_read_b64_tr_b16 v[136:137], v233 offset:4096
    ds_read_b64_tr_b16 v[138:139], v233 offset:5120
    buffer_load_dwordx4 v[164:167], v238, s[16:19], s41 offen offset:3072
    s_waitcnt lgkmcnt(15)
    v_mfma_f32_16x16x32_bf16 v[128:131], v[144:147], v[60:63], v[128:131]
    ds_read_b64_tr_b16 v[140:141], v224 offset:6144
    ds_read_b64_tr_b16 v[142:143], v224 offset:7168
    buffer_load_dwordx4 v[168:171], v238, s[16:19], s42 offen offset:0
    buffer_load_dwordx4 v[60:63], v238, s[16:19], s46 offen offset:1024
    s_waitcnt lgkmcnt(15)
    v_mfma_f32_16x16x32_bf16 v[120:123], v[148:151], v[64:67], v[120:123]
    ds_read_b64_tr_b16 v[144:145], v225 offset:6144
    ds_read_b64_tr_b16 v[146:147], v225 offset:7168
    buffer_load_dwordx4 v[172:175], v238, s[16:19], s42 offen offset:1024
    s_waitcnt lgkmcnt(14)
    v_mfma_f32_16x16x32_bf16 v[124:127], v[152:155], v[64:67], v[124:127]
    ds_read_b64_tr_b16 v[148:149], v226 offset:6144
    ds_read_b64_tr_b16 v[150:151], v226 offset:7168
    buffer_load_dwordx4 v[176:179], v238, s[16:19], s42 offen offset:2048
    s_waitcnt lgkmcnt(12)
    v_mfma_f32_16x16x32_bf16 v[128:131], v[156:159], v[64:67], v[128:131]
    ds_read_b64_tr_b16 v[152:153], v231 offset:6144
    ds_read_b64_tr_b16 v[154:155], v231 offset:7168
    buffer_load_dwordx4 v[180:183], v238, s[16:19], s42 offen offset:3072
    buffer_load_dwordx4 v[64:67], v238, s[16:19], s46 offen offset:2048
    s_waitcnt lgkmcnt(12)
    v_mfma_f32_16x16x32_bf16 v[120:123], v[160:163], v[68:71], v[120:123]
    ds_read_b64_tr_b16 v[156:157], v232 offset:6144
    ds_read_b64_tr_b16 v[158:159], v232 offset:7168
    buffer_load_dwordx4 v[184:187], v238, s[16:19], s43 offen offset:0
    s_waitcnt lgkmcnt(12)
    v_mfma_f32_16x16x32_bf16 v[124:127], v[132:135], v[68:71], v[124:127]
    ds_read_b64_tr_b16 v[160:161], v233 offset:6144
    ds_read_b64_tr_b16 v[162:163], v233 offset:7168
    buffer_load_dwordx4 v[188:191], v238, s[16:19], s43 offen offset:1024
    s_waitcnt lgkmcnt(12)
    v_mfma_f32_16x16x32_bf16 v[128:131], v[136:139], v[68:71], v[128:131]
    buffer_load_dwordx4 v[68:71], v238, s[16:19], s46 offen offset:3072
    s_waitcnt lgkmcnt(10)
    v_mfma_f32_16x16x32_bf16 v[120:123], v[140:143], v[72:75], v[120:123]
    s_waitcnt lgkmcnt(8)
    v_mfma_f32_16x16x32_bf16 v[124:127], v[144:147], v[72:75], v[124:127]
    s_waitcnt lgkmcnt(6)
    v_mfma_f32_16x16x32_bf16 v[128:131], v[148:151], v[72:75], v[128:131]
    s_waitcnt lgkmcnt(4)
    v_mfma_f32_16x16x32_bf16 v[120:123], v[152:155], v[76:79], v[120:123]
    s_waitcnt lgkmcnt(2)
    v_mfma_f32_16x16x32_bf16 v[124:127], v[156:159], v[76:79], v[124:127]
    s_waitcnt lgkmcnt(0)
    v_mfma_f32_16x16x32_bf16 v[128:131], v[160:163], v[76:79], v[128:131]
    s_cmp_lg_u32 s34, 0
    s_cbranch_scc1 KF_npa
    buffer_load_dword v11, v5, s[16:19], s39 offen offset:0 sc1
KF_npa:
    s_nop 0
    v_cvt_pk_bf16_f32 v200, v120, v121
    v_cvt_pk_bf16_f32 v201, v122, v123
    v_lshlrev_b32 v120, 16, v200
    v_and_b32 v121, 0xffff0000, v200
    v_lshlrev_b32 v122, 16, v201
    v_and_b32 v123, 0xffff0000, v201
    v_mul_f32 v204, s53, v120
    v_mul_f32 v205, s53, v121
    v_mul_f32 v206, s53, v122
    v_mul_f32 v207, s53, v123
    v_exp_f32 v204, v204
    v_exp_f32 v205, v205
    v_exp_f32 v206, v206
    v_exp_f32 v207, v207
    v_add_f32 v204, 1.0, v204
    v_add_f32 v205, 1.0, v205
    v_add_f32 v206, 1.0, v206
    v_add_f32 v207, 1.0, v207
    v_rcp_f32 v204, v204
    v_rcp_f32 v205, v205
    v_rcp_f32 v206, v206
    v_rcp_f32 v207, v207
    v_mul_f32 v120, v120, v204
    v_mul_f32 v121, v121, v205
    v_mul_f32 v122, v122, v206
    v_mul_f32 v123, v123, v207
    v_cvt_pk_bf16_f32 v192, v120, v121
    v_cvt_pk_bf16_f32 v193, v122, v123
    v_cvt_pk_bf16_f32 v202, v124, v125
    v_cvt_pk_bf16_f32 v203, v126, v127
    v_lshlrev_b32 v124, 16, v202
    v_and_b32 v125, 0xffff0000, v202
    v_lshlrev_b32 v126, 16, v203
    v_and_b32 v127, 0xffff0000, v203
    v_mul_f32 v204, s53, v124
    v_mul_f32 v205, s53, v125
    v_mul_f32 v206, s53, v126
    v_mul_f32 v207, s53, v127
    v_exp_f32 v204, v204
    v_exp_f32 v205, v205
    v_exp_f32 v206, v206
    v_exp_f32 v207, v207
    v_add_f32 v204, 1.0, v204
    v_add_f32 v205, 1.0, v205
    v_add_f32 v206, 1.0, v206
    v_add_f32 v207, 1.0, v207
    v_rcp_f32 v204, v204
    v_rcp_f32 v205, v205
    v_rcp_f32 v206, v206
    v_rcp_f32 v207, v207
    v_mul_f32 v124, v124, v204
    v_mul_f32 v125, v125, v205
    v_mul_f32 v126, v126, v206
    v_mul_f32 v127, v127, v207
    v_cvt_pk_bf16_f32 v194, v124, v125
    v_cvt_pk_bf16_f32 v195, v126, v127
    s_cmp_eq_u32 s34, 0
    s_cbranch_scc1 KF_nst5
    buffer_store_dwordx4 v[192:195], v1, s[16:19], s3 offen sc1
KF_nst5:
    v_cvt_pk_bf16_f32 v200, v128, v129
    v_cvt_pk_bf16_f32 v201, v130, v131
    v_lshlrev_b32 v128, 16, v200
    v_and_b32 v129, 0xffff0000, v200
    v_lshlrev_b32 v130, 16, v201
    v_and_b32 v131, 0xffff0000, v201
    v_mul_f32 v204, s53, v128
    v_mul_f32 v205, s53, v129
    v_mul_f32 v206, s53, v130
    v_mul_f32 v207, s53, v131
    v_exp_f32 v204, v204
    v_exp_f32 v205, v205
    v_exp_f32 v206, v206
    v_exp_f32 v207, v207
    v_add_f32 v204, 1.0, v204
    v_add_f32 v205, 1.0, v205
    v_add_f32 v206, 1.0, v206
    v_add_f32 v207, 1.0, v207
    v_rcp_f32 v204, v204
    v_rcp_f32 v205, v205
    v_rcp_f32 v206, v206
    v_rcp_f32 v207, v207
    v_mul_f32 v128, v128, v204
    v_mul_f32 v129, v129, v205
    v_mul_f32 v130, v130, v206
    v_mul_f32 v131, v131, v207
    v_cvt_pk_bf16_f32 v196, v128, v129
    v_cvt_pk_bf16_f32 v197, v130, v131
    s_cmp_eq_u32 s34, 0
    s_cbranch_scc1 KF_nst6
    v_lshrrev_b32 v204, 1, v15
    v_lshlrev_b32 v204, 8, v204
    v_lshl_add_u32 v204, v14, 4, v204
    v_permlane16_swap_b32 v196, v198
    v_permlane16_swap_b32 v197, v199
    s_mov_b32 exec_lo, 0xffff
    s_mov_b32 exec_hi, 0xffff
    buffer_store_dwordx4 v[196:199], v204, s[16:19], s59 offen sc1
    s_mov_b64 exec, -1
KF_nst6:
    s_cmp_lg_u32 s34, 0
    s_cbranch_scc1 KF_pae
    s_movk_i32 s61, 16384
    s_waitcnt vmcnt(0)
KF_pal:
    s_nop 7
    s_nop 3
    v_subrev_u32 v11, s20, v11
    v_cmp_lt_u32 vcc, s22, v11
    s_cbranch_vccz KF_pad
    s_sub_u32 s61, s61, 1
    s_cbranch_scc1 KF_pad
    s_add_u32 s49, s39, 128
    s_and_b32 s48, s61, 7
    s_cselect_b32 s48, s39, s49
    buffer_load_dword v11, v5, s[16:19], s48 offen offset:0 sc1
    s_waitcnt vmcnt(0)
    s_branch KF_pal
KF_st4:
    s_branch KF_ret
KF_pad:
    s_nop 7
    s_nop 3
    buffer_store_dwordx4 v[192:195], v1, s[16:19], s3 offen sc1
    v_lshrrev_b32 v204, 1, v15
    v_lshlrev_b32 v204, 8, v204
    v_lshl_add_u32 v204, v14, 4, v204
    v_permlane16_swap_b32 v196, v198
    v_permlane16_swap_b32 v197, v199
    s_mov_b32 exec_lo, 0xffff
    s_mov_b32 exec_hi, 0xffff
    buffer_store_dwordx4 v[196:199], v204, s[16:19], s59 offen sc1
    s_mov_b64 exec, -1
KF_pae:
    s_barrier
    s_add_u32 m0, s52, 8192
    s_nop 0
    buffer_load_dwordx4 v241, s[16:19], s40 offen offset:0 lds
    buffer_load_dwordx4 v241, s[16:19], s40 offen offset:1024 lds
    s_barrier
    s_add_u32 m0, s52, 10240
    s_nop 0
    buffer_load_dwordx4 v241, s[16:19], s41 offen offset:0 lds
    buffer_load_dwordx4 v241, s[16:19], s41 offen offset:1024 lds
    s_barrier
    s_waitcnt vmcnt(4)
    v_mov_b32 v8, 151572
    v_mov_b32 v9, 1
    s_mov_b64 exec, 1
    ds_add_rtn_u32 v10, v8, v9
    s_mov_b64 exec, -1
    s_waitcnt lgkmcnt(0)
    v_readfirstlane_b32 s48, v10
    s_nop 1
    s_cmp_lg_u32 s48, 7
    s_cbranch_scc1 KF_nfb
    v_mov_b32 v9, s100
    v_mov_b32 v8, 0
    s_mov_b64 exec, 1
    buffer_store_dword v9, v8, s[16:19], s37 offen offset:256
    buffer_store_dword v9, v8, s[16:19], s37 offen offset:384 sc1
    s_mov_b64 exec, -1
KF_nfb:
    s_nop 7
    s_nop 3
    s_lshr_b32 s48, s34, 2
    s_mul_i32 s49, s48, 113664
    v_subrev_u32 v241, s49, v241
    s_lshl_b32 s49, s48, 16
    v_subrev_u32 v240, s49, v240
    s_and_b32 s24, s34, 3
    s_lshl_b32 s24, s24, 14
    s_lshl_b32 s49, s48, 10
    s_add_u32 s24, s24, s49
    s_lshl_b32 s49, s63, 16
    s_add_u32 s25, s24, s49
    s_xor_b32 s24, s25, 65536
    s_mul_i32 s27, s63, 114688
    s_sub_u32 s26, 114688, s27
    s_cmp_lg_u32 s48, 0
    s_cselect_b32 s80, s81, s80
    s_cselect_b32 s82, s83, s82
    s_cselect_b32 s84, s85, s84
    s_cselect_b32 s86, s87, s86
    s_add_u32 s81, s80, s49
    s_xor_b32 s80, s81, 65536
    s_add_u32 s83, s82, s49
    s_xor_b32 s82, s83, 65536
    s_add_u32 s85, s84, s49
    s_xor_b32 s84, s85, 65536
    s_add_u32 s87, s86, s49
    s_xor_b32 s86, s87, 65536
    s_add_u32 m0, s24, 12288
    s_add_u32 s48, s42, s26
    buffer_load_dwordx4 v241, s[16:19], s48 offen lds
    s_add_u32 m0, s24, 14336
    s_add_u32 s48, s43, s26
    buffer_load_dwordx4 v241, s[16:19], s48 offen lds
    s_waitcnt vmcnt(4)
    s_barrier
    ds_read_b128 v[132:135], v242 offset:8192
    ds_read_b128 v[136:139], v242 offset:40960
    ds_read_b128 v[140:143], v243 offset:8192
    ds_read_b128 v[144:147], v243 offset:40960
    ds_read_b128 v[148:151], v242 offset:9216
    ds_read_b128 v[152:155], v242 offset:41984
    ds_read_b128 v[156:159], v243 offset:9216
    s_waitcnt vmcnt(36)
    s_waitcnt lgkmcnt(6)
    v_mfma_f32_16x16x32_bf16 v[220:223], v[80:83], v[132:135], 0
    ds_read_b128 v[160:163], v243 offset:41984
    s_waitcnt lgkmcnt(6)
    v_mfma_f32_16x16x32_bf16 v[224:227], v[80:83], v[136:139], 0
    ds_read_b128 v[132:135], v242 offset:24576
    buffer_load_dwordx4 v[72:75], v236, s[16:19], s72 offen
    s_waitcnt lgkmcnt(6)
    v_mfma_f32_16x16x32_bf16 v[228:231], v[80:83], v[140:143], 0
    ds_read_b128 v[136:139], v242 offset:57344
    buffer_load_dwordx4 v[76:79], v237, s[16:19], s72 offen
    s_waitcnt lgkmcnt(6)
    v_mfma_f32_16x16x32_bf16 v[232:235], v[80:83], v[144:147], 0
    ds_read_b128 v[140:143], v243 offset:24576
    buffer_load_dwordx4 v[244:247], v236, s[16:19], s73 offen
    s_waitcnt lgkmcnt(6)
    v_mfma_f32_16x16x32_bf16 v[220:223], v[84:87], v[148:151], v[220:223]
    ds_read_b128 v[144:147], v243 offset:57344
    buffer_load_dwordx4 v[208:211], v237, s[16:19], s73 offen
    s_waitcnt lgkmcnt(6)
    v_mfma_f32_16x16x32_bf16 v[224:227], v[84:87], v[152:155], v[224:227]
    ds_read_b128 v[148:151], v242 offset:25600
    buffer_load_dwordx4 v[212:215], v236, s[16:19], s74 offen
    s_waitcnt lgkmcnt(6)
    v_mfma_f32_16x16x32_bf16 v[228:231], v[84:87], v[156:159], v[228:231]
    ds_read_b128 v[152:155], v242 offset:58368
    buffer_load_dwordx4 v[216:219], v237, s[16:19], s74 offen
    s_waitcnt lgkmcnt(6)
    v_mfma_f32_16x16x32_bf16 v[232:235], v[84:87], v[160:163], v[232:235]
    ds_read_b128 v[156:159], v243 offset:25600
    buffer_load_dwordx4 v[192:195], v236, s[16:19], s75 offen
    s_waitcnt lgkmcnt(6)
    v_mfma_f32_16x16x32_bf16 v[220:223], v[88:91], v[132:135], v[220:223]
    ds_read_b128 v[160:163], v243 offset:58368
    buffer_load_dwordx4 v[196:199], v237, s[16:19], s75 offen
    s_waitcnt vmcnt(10)
    s_barrier
    s_waitcnt lgkmcnt(6)
    v_mfma_f32_16x16x32_bf16 v[224:227], v[88:91], v[136:139], v[224:227]
    ds_read_b128 v[132:135], v242 offset:10240
    buffer_load_dword v11, v5, s[16:19], s39 offen offset:256 sc1
    buffer_load_dwordx4 v[200:203], v236, s[16:19], s76 offen
    s_waitcnt lgkmcnt(6)
    v_mfma_f32_16x16x32_bf16 v[228:231], v[88:91], v[140:143], v[228:231]
    ds_read_b128 v[136:139], v242 offset:43008
    buffer_load_dwordx4 v[204:207], v237, s[16:19], s76 offen
    s_waitcnt lgkmcnt(6)
    v_mfma_f32_16x16x32_bf16 v[232:235], v[88:91], v[144:147], v[232:235]
    ds_read_b128 v[140:143], v243 offset:10240
    s_waitcnt lgkmcnt(6)
    v_mfma_f32_16x16x32_bf16 v[220:223], v[92:95], v[148:151], v[220:223]
    ds_read_b128 v[144:147], v243 offset:43008
    s_waitcnt lgkmcnt(6)
    v_mfma_f32_16x16x32_bf16 v[224:227], v[92:95], v[152:155], v[224:227]
    ds_read_b128 v[148:151], v242 offset:11264
    s_waitcnt lgkmcnt(6)
    v_mfma_f32_16x16x32_bf16 v[228:231], v[92:95], v[156:159], v[228:231]
    ds_read_b128 v[152:155], v242 offset:44032
    s_waitcnt lgkmcnt(6)
    v_mfma_f32_16x16x32_bf16 v[232:235], v[92:95], v[160:163], v[232:235]
    ds_read_b128 v[156:159], v243 offset:11264
    s_waitcnt vmcnt(28)
    s_waitcnt lgkmcnt(6)
    v_mfma_f32_16x16x32_bf16 v[220:223], v[96:99], v[132:135], v[220:223]
    ds_read_b128 v[160:163], v243 offset:44032
    buffer_load_dwordx4 v[80:83], v236, s[16:19], s77 offen
    s_waitcnt lgkmcnt(6)
    v_mfma_f32_16x16x32_bf16 v[224:227], v[96:99], v[136:139], v[224:227]
    ds_read_b128 v[132:135], v242 offset:26624
    buffer_load_dwordx4 v[84:87], v237, s[16:19], s77 offen
    s_waitcnt lgkmcnt(6)
    v_mfma_f32_16x16x32_bf16 v[228:231], v[96:99], v[140:143], v[228:231]
    ds_read_b128 v[136:139], v242 offset:59392
    buffer_load_dwordx4 v[88:91], v236, s[16:19], s78 offen
    s_waitcnt lgkmcnt(6)
    v_mfma_f32_16x16x32_bf16 v[232:235], v[96:99], v[144:147], v[232:235]
    ds_read_b128 v[140:143], v243 offset:26624
    buffer_load_dwordx4 v[92:95], v237, s[16:19], s78 offen
    s_waitcnt lgkmcnt(6)
    v_mfma_f32_16x16x32_bf16 v[220:223], v[100:103], v[148:151], v[220:223]
    ds_read_b128 v[144:147], v243 offset:59392
    s_movk_i32 s61, 16384
    s_waitcnt vmcnt(6)
KF_pbl:
    s_nop 7
    s_nop 3
    v_subrev_u32 v11, s20, v11
    v_cmp_lt_u32 vcc, s22, v11
    s_cbranch_vccz KF_pbd
    s_sub_u32 s61, s61, 1
    s_cbranch_scc1 KF_pbd
    s_add_u32 s49, s39, 128
    s_and_b32 s48, s61, 7
    s_cselect_b32 s48, s39, s49
    buffer_load_dword v11, v5, s[16:19], s48 offen offset:256 sc1
    s_waitcnt vmcnt(0)
    s_branch KF_pbl
KF_st5:
    s_branch KF_ret
KF_pbd:
    s_nop 7
    s_nop 3
    s_add_u32 m0, s24, 0
    s_add_u32 s48, s44, s26
    buffer_load_dwordx4 v241, s[16:19], s48 offen lds
    s_add_u32 m0, s24, 2048
    s_add_u32 s48, s45, s26
    buffer_load_dwordx4 v241, s[16:19], s48 offen lds
    s_add_u32 m0, s24, 4096
    s_add_u32 s48, s46, s26
    buffer_load_dwordx4 v241, s[16:19], s48 offen lds
    s_waitcnt lgkmcnt(6)
    v_mfma_f32_16x16x32_bf16 v[224:227], v[100:103], v[152:155], v[224:227]
    ds_read_b128 v[148:151], v242 offset:27648
    s_add_u32 m0, s24, 6144
    s_nop 0
    buffer_load_dwordx4 v240, s[16:19], s80 offen lds
    s_waitcnt lgkmcnt(6)
    v_mfma_f32_16x16x32_bf16 v[228:231], v[100:103], v[156:159], v[228:231]
    ds_read_b128 v[152:155], v242 offset:60416
    s_add_u32 m0, s25, 0
    s_nop 0
    buffer_load_dwordx4 v240, s[16:19], s82 offen lds
    s_waitcnt lgkmcnt(6)
    v_mfma_f32_16x16x32_bf16 v[232:235], v[100:103], v[160:163], v[232:235]
    ds_read_b128 v[156:159], v243 offset:27648
    s_add_u32 m0, s25, 2048
    s_nop 0
    buffer_load_dwordx4 v240, s[16:19], s84 offen lds
    s_waitcnt lgkmcnt(6)
    v_mfma_f32_16x16x32_bf16 v[220:223], v[248:251], v[132:135], v[220:223]
    ds_read_b128 v[160:163], v243 offset:60416
    s_add_u32 m0, s25, 4096
    s_nop 0
    buffer_load_dwordx4 v240, s[16:19], s86 offen lds
    s_waitcnt vmcnt(23)
    s_barrier
    s_waitcnt lgkmcnt(6)
    v_mfma_f32_16x16x32_bf16 v[224:227], v[248:251], v[136:139], v[224:227]
    ds_read_b128 v[132:135], v242 offset:12288
    s_waitcnt lgkmcnt(6)
    v_mfma_f32_16x16x32_bf16 v[228:231], v[248:251], v[140:143], v[228:231]
    ds_read_b128 v[136:139], v242 offset:45056
    s_waitcnt lgkmcnt(6)
    v_mfma_f32_16x16x32_bf16 v[232:235], v[248:251], v[144:147], v[232:235]
    ds_read_b128 v[140:143], v242 offset:13312
    s_waitcnt lgkmcnt(6)
    v_mfma_f32_16x16x32_bf16 v[220:223], v[164:167], v[148:151], v[220:223]
    ds_read_b128 v[144:147], v242 offset:46080
    s_waitcnt lgkmcnt(6)
    v_mfma_f32_16x16x32_bf16 v[224:227], v[164:167], v[152:155], v[224:227]
    ds_read_b128 v[148:151], v242 offset:28672
    s_waitcnt lgkmcnt(6)
    v_mfma_f32_16x16x32_bf16 v[228:231], v[164:167], v[156:159], v[228:231]
    ds_read_b128 v[152:155], v242 offset:61440
    s_waitcnt lgkmcnt(6)
    v_mfma_f32_16x16x32_bf16 v[232:235], v[164:167], v[160:163], v[232:235]
    ds_read_b128 v[156:159], v242 offset:29696
    s_waitcnt vmcnt(34)
    s_waitcnt lgkmcnt(6)
    v_mfma_f32_16x16x32_bf16 v[220:223], v[168:171], v[132:135], v[220:223]
    ds_read_b128 v[160:163], v242 offset:62464
    buffer_load_dwordx4 v[96:99], v236, s[16:19], s79 offen
    s_waitcnt vmcnt(23)
    s_barrier
    s_waitcnt lgkmcnt(6)
    v_mfma_f32_16x16x32_bf16 v[224:227], v[168:171], v[136:139], v[224:227]
    ds_read_b128 v[132:135], v242 offset:14336
    buffer_load_dwordx4 v[100:103], v237, s[16:19], s79 offen
    s_waitcnt lgkmcnt(6)
    v_mfma_f32_16x16x32_bf16 v[220:223], v[172:175], v[140:143], v[220:223]
    ds_read_b128 v[136:139], v242 offset:47104
    s_waitcnt lgkmcnt(6)
    v_mfma_f32_16x16x32_bf16 v[224:227], v[172:175], v[144:147], v[224:227]
    ds_read_b128 v[140:143], v242 offset:15360
    s_waitcnt lgkmcnt(6)
    v_mfma_f32_16x16x32_bf16 v[220:223], v[176:179], v[148:151], v[220:223]
    ds_read_b128 v[144:147], v242 offset:48128
    s_waitcnt lgkmcnt(6)
    v_mfma_f32_16x16x32_bf16 v[224:227], v[176:179], v[152:155], v[224:227]
    ds_read_b128 v[148:151], v242 offset:30720
    s_waitcnt lgkmcnt(6)
    v_mfma_f32_16x16x32_bf16 v[220:223], v[180:183], v[156:159], v[220:223]
    ds_read_b128 v[152:155], v242 offset:63488
    s_waitcnt lgkmcnt(6)
    v_mfma_f32_16x16x32_bf16 v[224:227], v[180:183], v[160:163], v[224:227]
    ds_read_b128 v[156:159], v242 offset:31744
    s_waitcnt vmcnt(33)
    s_waitcnt lgkmcnt(6)
    v_mfma_f32_16x16x32_bf16 v[220:223], v[184:187], v[132:135], v[220:223]
    ds_read_b128 v[160:163], v242 offset:64512
    s_add_u32 m0, s25, 12288
    s_add_u32 s48, s42, s27
    buffer_load_dwordx4 v241, s[16:19], s48 offen lds
    s_waitcnt vmcnt(9)
    s_barrier
    s_waitcnt lgkmcnt(6)
    v_mfma_f32_16x16x32_bf16 v[224:227], v[184:187], v[136:139], v[224:227]
    ds_read_b128 v[132:135], v242 offset:0
    s_add_u32 m0, s25, 14336
    s_add_u32 s48, s43, s27
    buffer_load_dwordx4 v241, s[16:19], s48 offen lds
    s_waitcnt lgkmcnt(6)
    v_mfma_f32_16x16x32_bf16 v[220:223], v[188:191], v[140:143], v[220:223]
    ds_read_b128 v[136:139], v242 offset:32768
    s_add_u32 m0, s25, 6144
    s_add_u32 s48, s44, s27
    buffer_load_dwordx4 v241, s[16:19], s48 offen lds
    s_waitcnt lgkmcnt(6)
    v_mfma_f32_16x16x32_bf16 v[224:227], v[188:191], v[144:147], v[224:227]
    ds_read_b128 v[140:143], v242 offset:1024
    s_add_u32 m0, s24, 8192
    s_add_u32 s48, s45, s27
    buffer_load_dwordx4 v241, s[16:19], s48 offen lds
    s_waitcnt lgkmcnt(6)
    v_mfma_f32_16x16x32_bf16 v[220:223], v[16:19], v[148:151], v[220:223]
    ds_read_b128 v[144:147], v242 offset:33792
    s_add_u32 m0, s25, 8192
    s_add_u32 s48, s46, s27
    buffer_load_dwordx4 v241, s[16:19], s48 offen lds
    s_waitcnt lgkmcnt(6)
    v_mfma_f32_16x16x32_bf16 v[224:227], v[16:19], v[152:155], v[224:227]
    ds_read_b128 v[148:151], v242 offset:16384
    s_add_u32 m0, s24, 10240
    s_nop 0
    buffer_load_dwordx4 v240, s[16:19], s81 offen lds
    s_waitcnt lgkmcnt(6)
    v_mfma_f32_16x16x32_bf16 v[220:223], v[20:23], v[156:159], v[220:223]
    ds_read_b128 v[152:155], v242 offset:49152
    s_add_u32 m0, s25, 10240
    s_nop 0
    buffer_load_dwordx4 v240, s[16:19], s83 offen lds
    s_waitcnt lgkmcnt(6)
    v_mfma_f32_16x16x32_bf16 v[224:227], v[20:23], v[160:163], v[224:227]
    ds_read_b128 v[156:159], v242 offset:17408
    s_add_u32 m0, s24, 12288
    s_nop 0
    buffer_load_dwordx4 v240, s[16:19], s85 offen lds
    s_waitcnt vmcnt(57)
    s_waitcnt lgkmcnt(6)
    v_mfma_f32_16x16x32_bf16 v[220:223], v[24:27], v[132:135], v[220:223]
    ds_read_b128 v[160:163], v242 offset:50176
    s_waitcnt vmcnt(15)
    s_barrier
    s_waitcnt lgkmcnt(6)
    v_mfma_f32_16x16x32_bf16 v[224:227], v[24:27], v[136:139], v[224:227]
    ds_read_b128 v[132:135], v242 offset:2048
    s_add_u32 m0, s24, 14336
    s_nop 0
    buffer_load_dwordx4 v240, s[16:19], s87 offen lds
    s_waitcnt lgkmcnt(6)
    v_mfma_f32_16x16x32_bf16 v[220:223], v[28:31], v[140:143], v[220:223]
    ds_read_b128 v[136:139], v242 offset:34816
    s_waitcnt lgkmcnt(6)
    v_mfma_f32_16x16x32_bf16 v[224:227], v[28:31], v[144:147], v[224:227]
    ds_read_b128 v[140:143], v242 offset:3072
    s_waitcnt lgkmcnt(6)
    v_mfma_f32_16x16x32_bf16 v[220:223], v[32:35], v[148:151], v[220:223]
    ds_read_b128 v[144:147], v242 offset:35840
    s_waitcnt lgkmcnt(6)
    v_mfma_f32_16x16x32_bf16 v[224:227], v[32:35], v[152:155], v[224:227]
    ds_read_b128 v[148:151], v242 offset:18432
    s_waitcnt lgkmcnt(6)
    v_mfma_f32_16x16x32_bf16 v[220:223], v[36:39], v[156:159], v[220:223]
    ds_read_b128 v[152:155], v242 offset:51200
    s_waitcnt lgkmcnt(6)
    v_mfma_f32_16x16x32_bf16 v[224:227], v[36:39], v[160:163], v[224:227]
    ds_read_b128 v[156:159], v242 offset:19456
    s_waitcnt vmcnt(54)
    s_waitcnt lgkmcnt(6)
    v_mfma_f32_16x16x32_bf16 v[220:223], v[40:43], v[132:135], v[220:223]
    ds_read_b128 v[160:163], v242 offset:52224
    s_waitcnt vmcnt(15)
    s_barrier
    s_waitcnt lgkmcnt(6)
    v_mfma_f32_16x16x32_bf16 v[224:227], v[40:43], v[136:139], v[224:227]
    ds_read_b128 v[132:135], v242 offset:4096
    s_waitcnt lgkmcnt(6)
    v_mfma_f32_16x16x32_bf16 v[220:223], v[44:47], v[140:143], v[220:223]
    ds_read_b128 v[136:139], v242 offset:36864
    s_waitcnt lgkmcnt(6)
    v_mfma_f32_16x16x32_bf16 v[224:227], v[44:47], v[144:147], v[224:227]
    ds_read_b128 v[140:143], v242 offset:5120
    s_waitcnt lgkmcnt(6)
    v_mfma_f32_16x16x32_bf16 v[220:223], v[48:51], v[148:151], v[220:223]
    ds_read_b128 v[144:147], v242 offset:37888
    s_lshl_b32 s48, s32, 7
    s_lshl_b32 s49, s62, 5
    s_add_u32 s48, s48, s49
    v_add_u32 v12, s48, v14
    v_lshlrev_b32 v12, 10, v12
    s_and_b32 s48, s33, 3
    s_lshl_b32 s48, s48, 8
    s_lshl_b32 s49, s34, 5
    s_add_u32 s48, s48, s49
    v_lshl_add_u32 v13, v15, 3, s48
    v_add_u32 v12, v12, v13
    s_movk_i32 s49, 16384
    buffer_load_dwordx2 v[248:249], v12, s[4:7], 0 offen
    buffer_load_dwordx2 v[250:251], v12, s[4:7], s49 offen
    v_lshlrev_b32 v12, 1, v12
    s_lshl_b32 s48, s48, 4
    s_lshl_b32 s49, s62, 15
    s_add_u32 s48, s48, s49
    s_add_u32 s48, s48, s21
    s_add_u32 s48, s48, 0
    s_add_u32 s49, s48, 16384
    v_lshrrev_b32 v4, 1, v15
    v_lshlrev_b32 v4, 8, v4
    v_lshl_add_u32 v4, v14, 4, v4
    v_and_b32 v3, 1, v15
    v_lshl_add_u32 v4, v3, 3, v4
    buffer_load_dwordx2 v[126:127], v4, s[16:19], s48 offen
    buffer_load_dwordx2 v[128:129], v4, s[16:19], s49 offen
    s_mov_b32 s12, s88
    s_and_b32 s13, s89, 0xffff
    s_mov_b32 s14, 1024
    s_mov_b32 s15, 0x00020000
    s_mov_b32 s8, s90
    s_and_b32 s9, s91, 0xffff
    s_mov_b32 s10, 4194304
    s_mov_b32 s11, 0x00020000
    buffer_load_dwordx2 v[130:131], v13, s[12:15], 0 offen
    s_waitcnt lgkmcnt(6)
    v_mfma_f32_16x16x32_bf16 v[224:227], v[48:51], v[152:155], v[224:227]
    ds_read_b128 v[148:151], v242 offset:20480
    s_waitcnt lgkmcnt(6)
    v_mfma_f32_16x16x32_bf16 v[220:223], v[52:55], v[156:159], v[220:223]
    ds_read_b128 v[152:155], v242 offset:53248
    s_waitcnt lgkmcnt(6)
    v_mfma_f32_16x16x32_bf16 v[224:227], v[52:55], v[160:163], v[224:227]
    ds_read_b128 v[156:159], v242 offset:21504
    s_waitcnt vmcnt(46)
    s_waitcnt lgkmcnt(6)
    v_mfma_f32_16x16x32_bf16 v[220:223], v[56:59], v[132:135], v[220:223]
    ds_read_b128 v[160:163], v242 offset:54272
    s_waitcnt vmcnt(19)
    s_barrier
    s_waitcnt lgkmcnt(6)
    v_mfma_f32_16x16x32_bf16 v[224:227], v[56:59], v[136:139], v[224:227]
    ds_read_b128 v[132:135], v242 offset:6144
    s_waitcnt lgkmcnt(6)
    v_mfma_f32_16x16x32_bf16 v[220:223], v[60:63], v[140:143], v[220:223]
    ds_read_b128 v[136:139], v242 offset:38912
    s_waitcnt lgkmcnt(6)
    v_mfma_f32_16x16x32_bf16 v[224:227], v[60:63], v[144:147], v[224:227]
    ds_read_b128 v[140:143], v242 offset:22528
    s_waitcnt lgkmcnt(6)
    v_mfma_f32_16x16x32_bf16 v[220:223], v[64:67], v[148:151], v[220:223]
    ds_read_b128 v[144:147], v242 offset:55296
    s_lshl_b32 s48, s38, 16
    s_lshl_b32 s49, s34, 13
    s_add_u32 s48, s48, s49
    s_add_u32 s58, s48, 27262976
    s_xor_b32 s57, s58, 524288
    s_add_u32 s54, s58, 4096
    s_add_u32 s55, s57, 4096
    v_mov_b32 v120, s100
    v_mov_b32 v124, 0xffffff00
    v_lshrrev_b32 v121, 8, v120
    v_lshrrev_b32 v122, 16, v120
    v_lshrrev_b32 v123, 24, v120
    s_waitcnt lgkmcnt(6)
    v_mfma_f32_16x16x32_bf16 v[224:227], v[64:67], v[152:155], v[224:227]
    ds_read_b128 v[148:151], v242 offset:7168
    s_waitcnt lgkmcnt(6)
    v_mfma_f32_16x16x32_bf16 v[220:223], v[68:71], v[156:159], v[220:223]
    ds_read_b128 v[152:155], v242 offset:39936
    s_waitcnt lgkmcnt(6)
    v_mfma_f32_16x16x32_bf16 v[224:227], v[68:71], v[160:163], v[224:227]
    ds_read_b128 v[156:159], v242 offset:23552
    s_waitcnt vmcnt(36)
    s_waitcnt lgkmcnt(6)
    v_mfma_f32_16x16x32_f16 v[104:107], v[72:75], v[132:135], 0
    ds_read_b128 v[160:163], v242 offset:56320
    s_waitcnt vmcnt(18)
    s_barrier
    s_waitcnt lgkmcnt(6)
    v_mfma_f32_16x16x32_f16 v[108:111], v[72:75], v[136:139], 0
    ds_read_b128 v[132:135], v243 offset:0
    s_waitcnt lgkmcnt(6)
    v_mfma_f32_16x16x32_f16 v[104:107], v[76:79], v[140:143], v[104:107]
    ds_read_b128 v[136:139], v243 offset:32768
    s_waitcnt lgkmcnt(6)
    v_mfma_f32_16x16x32_f16 v[108:111], v[76:79], v[144:147], v[108:111]
    ds_read_b128 v[140:143], v243 offset:16384
    v_add_u32 v220, 0x80, v220
    v_add_u32 v221, 0x80, v221
    v_add_u32 v222, 0x80, v222
    v_add_u32 v223, 0x80, v223
    v_add_u32 v224, 0x80, v224
    v_add_u32 v225, 0x80, v225
    s_waitcnt vmcnt(34)
    s_waitcnt lgkmcnt(6)
    v_mfma_f32_16x16x32_f16 v[104:107], v[244:247], v[148:151], v[104:107]
    ds_read_b128 v[144:147], v243 offset:49152
    v_add_u32 v226, 0x80, v226
    v_add_u32 v227, 0x80, v227
    v_bfi_b32 v220, v124, v220, v120
    v_bfi_b32 v221, v124, v221, v121
    v_bfi_b32 v222, v124, v222, v122
    v_bfi_b32 v223, v124, v223, v123
    s_waitcnt lgkmcnt(6)
    v_mfma_f32_16x16x32_f16 v[108:111], v[244:247], v[152:155], v[108:111]
    ds_read_b128 v[148:151], v243 offset:1024
    v_bfi_b32 v224, v124, v224, v120
    v_bfi_b32 v225, v124, v225, v121
    v_bfi_b32 v226, v124, v226, v122
    v_bfi_b32 v227, v124, v227, v123
    buffer_store_dwordx4 v[220:223], v1, s[16:19], s57 offen offset:0 sc1
    buffer_store_dwordx4 v[224:227], v1, s[16:19], s57 offen offset:1024 sc1
    s_waitcnt lgkmcnt(6)
    v_mfma_f32_16x16x32_f16 v[104:107], v[208:211], v[156:159], v[104:107]
    ds_read_b128 v[152:155], v243 offset:33792
    s_waitcnt lgkmcnt(6)
    v_mfma_f32_16x16x32_f16 v[108:111], v[208:211], v[160:163], v[108:111]
    ds_read_b128 v[156:159], v243 offset:17408
    s_waitcnt vmcnt(34)
    s_waitcnt lgkmcnt(6)
    v_mfma_f32_16x16x32_f16 v[104:107], v[212:215], v[132:135], v[104:107]
    ds_read_b128 v[160:163], v243 offset:50176
    s_waitcnt vmcnt(19)
    s_barrier
    s_waitcnt lgkmcnt(6)
    v_mfma_f32_16x16x32_f16 v[108:111], v[212:215], v[136:139], v[108:111]
    ds_read_b128 v[132:135], v243 offset:2048
    s_waitcnt lgkmcnt(6)
    v_mfma_f32_16x16x32_f16 v[104:107], v[216:219], v[140:143], v[104:107]
    ds_read_b128 v[136:139], v243 offset:34816
    s_waitcnt lgkmcnt(6)
    v_mfma_f32_16x16x32_f16 v[108:111], v[216:219], v[144:147], v[108:111]
    ds_read_b128 v[140:143], v243 offset:18432
    s_waitcnt vmcnt(32)
    s_waitcnt lgkmcnt(6)
    v_mfma_f32_16x16x32_f16 v[104:107], v[192:195], v[148:151], v[104:107]
    ds_read_b128 v[144:147], v243 offset:51200
    s_waitcnt lgkmcnt(6)
    v_mfma_f32_16x16x32_f16 v[108:111], v[192:195], v[152:155], v[108:111]
    ds_read_b128 v[148:151], v243 offset:3072
    s_waitcnt lgkmcnt(6)
    v_mfma_f32_16x16x32_f16 v[104:107], v[196:199], v[156:159], v[104:107]
    ds_read_b128 v[152:155], v243 offset:35840
    s_waitcnt lgkmcnt(6)
    v_mfma_f32_16x16x32_f16 v[108:111], v[196:199], v[160:163], v[108:111]
    ds_read_b128 v[156:159], v243 offset:19456
    s_waitcnt vmcnt(29)
    s_waitcnt lgkmcnt(6)
    v_mfma_f32_16x16x32_f16 v[104:107], v[200:203], v[132:135], v[104:107]
    ds_read_b128 v[160:163], v243 offset:52224
    s_waitcnt vmcnt(18)
    s_barrier
    s_waitcnt lgkmcnt(6)
    v_mfma_f32_16x16x32_f16 v[108:111], v[200:203], v[136:139], v[108:111]
    ds_read_b128 v[132:135], v243 offset:4096
    s_waitcnt lgkmcnt(6)
    v_mfma_f32_16x16x32_f16 v[104:107], v[204:207], v[140:143], v[104:107]
    ds_read_b128 v[136:139], v243 offset:36864
    s_waitcnt lgkmcnt(6)
    v_mfma_f32_16x16x32_f16 v[108:111], v[204:207], v[144:147], v[108:111]
    ds_read_b128 v[140:143], v243 offset:20480
    s_waitcnt vmcnt(27)
    s_waitcnt lgkmcnt(6)
    v_mfma_f32_16x16x32_f16 v[104:107], v[80:83], v[148:151], v[104:107]
    ds_read_b128 v[144:147], v243 offset:53248
    s_waitcnt lgkmcnt(6)
    v_mfma_f32_16x16x32_f16 v[108:111], v[80:83], v[152:155], v[108:111]
    ds_read_b128 v[148:151], v243 offset:5120
    s_waitcnt lgkmcnt(6)
    v_mfma_f32_16x16x32_f16 v[104:107], v[84:87], v[156:159], v[104:107]
    ds_read_b128 v[152:155], v243 offset:37888
    s_waitcnt lgkmcnt(6)
    v_mfma_f32_16x16x32_f16 v[108:111], v[84:87], v[160:163], v[108:111]
    ds_read_b128 v[156:159], v243 offset:21504
    s_waitcnt vmcnt(25)
    s_waitcnt lgkmcnt(6)
    v_mfma_f32_16x16x32_f16 v[104:107], v[88:91], v[132:135], v[104:107]
    ds_read_b128 v[160:163], v243 offset:54272
    s_waitcnt vmcnt(14)
    s_barrier
    s_waitcnt lgkmcnt(6)
    v_mfma_f32_16x16x32_f16 v[108:111], v[88:91], v[136:139], v[108:111]
    ds_read_b128 v[132:135], v243 offset:12288
    s_waitcnt lgkmcnt(6)
    v_mfma_f32_16x16x32_f16 v[104:107], v[92:95], v[140:143], v[104:107]
    ds_read_b128 v[136:139], v243 offset:45056
    s_waitcnt lgkmcnt(6)
    v_mfma_f32_16x16x32_f16 v[108:111], v[92:95], v[144:147], v[108:111]
    ds_read_b128 v[140:143], v243 offset:13312
    s_waitcnt vmcnt(16)
    s_waitcnt lgkmcnt(6)
    v_mfma_f32_16x16x32_f16 v[104:107], v[96:99], v[148:151], v[104:107]
    ds_read_b128 v[144:147], v243 offset:46080
    s_waitcnt lgkmcnt(6)
    v_mfma_f32_16x16x32_f16 v[108:111], v[96:99], v[152:155], v[108:111]
    ds_read_b128 v[148:151], v243 offset:28672
    s_waitcnt lgkmcnt(6)
    v_mfma_f32_16x16x32_f16 v[104:107], v[100:103], v[156:159], v[104:107]
    ds_read_b128 v[152:155], v243 offset:61440
    s_waitcnt lgkmcnt(6)
    v_mfma_f32_16x16x32_f16 v[108:111], v[100:103], v[160:163], v[108:111]
    ds_read_b128 v[156:159], v243 offset:29696
    s_waitcnt lgkmcnt(6)
    v_mfma_f32_16x16x32_bf16 v[228:231], v[168:171], v[132:135], v[228:231]
    ds_read_b128 v[160:163], v243 offset:62464
    s_waitcnt lgkmcnt(6)
    v_mfma_f32_16x16x32_bf16 v[232:235], v[168:171], v[136:139], v[232:235]
    ds_read_b128 v[132:135], v243 offset:14336
    s_waitcnt lgkmcnt(6)
    v_mfma_f32_16x16x32_bf16 v[228:231], v[172:175], v[140:143], v[228:231]
    ds_read_b128 v[136:139], v243 offset:47104
    s_waitcnt lgkmcnt(6)
    v_mfma_f32_16x16x32_bf16 v[232:235], v[172:175], v[144:147], v[232:235]
    ds_read_b128 v[140:143], v243 offset:15360
    v_add_u32 v104, 0x80, v104
    v_add_u32 v105, 0x80, v105
    v_add_u32 v106, 0x80, v106
    v_add_u32 v107, 0x80, v107
    v_add_u32 v108, 0x80, v108
    v_add_u32 v109, 0x80, v109
    s_waitcnt lgkmcnt(6)
    v_mfma_f32_16x16x32_bf16 v[228:231], v[176:179], v[148:151], v[228:231]
    ds_read_b128 v[144:147], v243 offset:48128
    v_add_u32 v110, 0x80, v110
    v_add_u32 v111, 0x80, v111
    v_bfi_b32 v104, v124, v104, v120
    v_bfi_b32 v105, v124, v105, v121
    v_bfi_b32 v106, v124, v106, v122
    v_bfi_b32 v107, v124, v107, v123
    s_waitcnt lgkmcnt(6)
    v_mfma_f32_16x16x32_bf16 v[232:235], v[176:179], v[152:155], v[232:235]
    ds_read_b128 v[148:151], v243 offset:30720
    v_bfi_b32 v108, v124, v108, v120
    v_bfi_b32 v109, v124, v109, v121
    v_bfi_b32 v110, v124, v110, v122
    v_bfi_b32 v111, v124, v111, v123
    buffer_store_dwordx4 v[104:107], v1, s[16:19], s55 offen offset:0 sc1
    buffer_store_dwordx4 v[108:111], v1, s[16:19], s55 offen offset:1024 sc1
    s_waitcnt lgkmcnt(6)
    v_mfma_f32_16x16x32_bf16 v[228:231], v[180:183], v[156:159], v[228:231]
    ds_read_b128 v[152:155], v243 offset:63488
    s_waitcnt lgkmcnt(6)
    v_mfma_f32_16x16x32_bf16 v[232:235], v[180:183], v[160:163], v[232:235]
    ds_read_b128 v[156:159], v243 offset:31744
    s_waitcnt lgkmcnt(6)
    v_mfma_f32_16x16x32_bf16 v[228:231], v[184:187], v[132:135], v[228:231]
    ds_read_b128 v[160:163], v243 offset:64512
    s_waitcnt vmcnt(13)
    s_barrier
    s_waitcnt lgkmcnt(6)
    v_mfma_f32_16x16x32_bf16 v[232:235], v[184:187], v[136:139], v[232:235]
    ds_read_b128 v[132:135], v243 offset:6144
    s_waitcnt lgkmcnt(6)
    v_mfma_f32_16x16x32_bf16 v[228:231], v[188:191], v[140:143], v[228:231]
    ds_read_b128 v[136:139], v243 offset:38912
    s_waitcnt lgkmcnt(6)
    v_mfma_f32_16x16x32_bf16 v[232:235], v[188:191], v[144:147], v[232:235]
    ds_read_b128 v[140:143], v243 offset:7168
    s_waitcnt lgkmcnt(6)
    v_mfma_f32_16x16x32_bf16 v[228:231], v[16:19], v[148:151], v[228:231]
    ds_read_b128 v[144:147], v243 offset:39936
    s_waitcnt lgkmcnt(6)
    v_mfma_f32_16x16x32_bf16 v[232:235], v[16:19], v[152:155], v[232:235]
    ds_read_b128 v[148:151], v243 offset:22528
    s_waitcnt lgkmcnt(6)
    v_mfma_f32_16x16x32_bf16 v[228:231], v[20:23], v[156:159], v[228:231]
    ds_read_b128 v[152:155], v243 offset:55296
    s_waitcnt lgkmcnt(6)
    v_mfma_f32_16x16x32_bf16 v[232:235], v[20:23], v[160:163], v[232:235]
    ds_read_b128 v[156:159], v243 offset:23552
    s_waitcnt lgkmcnt(6)
    v_mfma_f32_16x16x32_bf16 v[228:231], v[24:27], v[132:135], v[228:231]
    ds_read_b128 v[160:163], v243 offset:56320
    s_waitcnt lgkmcnt(6)
    v_mfma_f32_16x16x32_bf16 v[232:235], v[24:27], v[136:139], v[232:235]
    ds_read_b128 v[132:135], v242 offset:8192
    s_waitcnt lgkmcnt(6)
    v_mfma_f32_16x16x32_bf16 v[228:231], v[28:31], v[140:143], v[228:231]
    ds_read_b128 v[136:139], v242 offset:40960
    s_waitcnt lgkmcnt(6)
    v_mfma_f32_16x16x32_bf16 v[232:235], v[28:31], v[144:147], v[232:235]
    ds_read_b128 v[140:143], v242 offset:9216
    s_waitcnt lgkmcnt(6)
    v_mfma_f32_16x16x32_bf16 v[228:231], v[32:35], v[148:151], v[228:231]
    ds_read_b128 v[144:147], v242 offset:41984
    s_waitcnt lgkmcnt(6)
    v_mfma_f32_16x16x32_bf16 v[232:235], v[32:35], v[152:155], v[232:235]
    ds_read_b128 v[148:151], v242 offset:24576
    s_waitcnt lgkmcnt(6)
    v_mfma_f32_16x16x32_bf16 v[228:231], v[36:39], v[156:159], v[228:231]
    ds_read_b128 v[152:155], v242 offset:57344
    s_waitcnt lgkmcnt(6)
    v_mfma_f32_16x16x32_bf16 v[232:235], v[36:39], v[160:163], v[232:235]
    ds_read_b128 v[156:159], v242 offset:25600
    s_waitcnt lgkmcnt(6)
    v_mfma_f32_16x16x32_bf16 v[228:231], v[40:43], v[132:135], v[228:231]
    ds_read_b128 v[160:163], v242 offset:58368
    s_waitcnt lgkmcnt(6)
    v_mfma_f32_16x16x32_bf16 v[232:235], v[40:43], v[136:139], v[232:235]
    ds_read_b128 v[132:135], v243 offset:8192
    s_waitcnt lgkmcnt(6)
    v_mfma_f32_16x16x32_bf16 v[228:231], v[44:47], v[140:143], v[228:231]
    ds_read_b128 v[136:139], v243 offset:40960
    s_waitcnt lgkmcnt(6)
    v_mfma_f32_16x16x32_bf16 v[232:235], v[44:47], v[144:147], v[232:235]
    ds_read_b128 v[140:143], v243 offset:9216
    s_waitcnt lgkmcnt(6)
    v_mfma_f32_16x16x32_bf16 v[228:231], v[48:51], v[148:151], v[228:231]
    ds_read_b128 v[144:147], v243 offset:41984
    s_waitcnt lgkmcnt(6)
    v_mfma_f32_16x16x32_bf16 v[232:235], v[48:51], v[152:155], v[232:235]
    ds_read_b128 v[148:151], v243 offset:24576
    s_waitcnt lgkmcnt(6)
    v_mfma_f32_16x16x32_bf16 v[228:231], v[52:55], v[156:159], v[228:231]
    ds_read_b128 v[152:155], v243 offset:57344
    s_waitcnt lgkmcnt(6)
    v_mfma_f32_16x16x32_bf16 v[232:235], v[52:55], v[160:163], v[232:235]
    ds_read_b128 v[156:159], v243 offset:25600
    s_waitcnt lgkmcnt(6)
    v_mfma_f32_16x16x32_bf16 v[228:231], v[56:59], v[132:135], v[228:231]
    ds_read_b128 v[160:163], v243 offset:58368
    s_waitcnt vmcnt(9)
    s_barrier
    s_waitcnt lgkmcnt(6)
    v_mfma_f32_16x16x32_bf16 v[232:235], v[56:59], v[136:139], v[232:235]
    ds_read_b128 v[132:135], v242 offset:10240
    s_waitcnt lgkmcnt(6)
    v_mfma_f32_16x16x32_bf16 v[228:231], v[60:63], v[140:143], v[228:231]
    ds_read_b128 v[136:139], v242 offset:43008
    s_waitcnt lgkmcnt(6)
    v_mfma_f32_16x16x32_bf16 v[232:235], v[60:63], v[144:147], v[232:235]
    ds_read_b128 v[140:143], v242 offset:26624
    s_waitcnt lgkmcnt(6)
    v_mfma_f32_16x16x32_bf16 v[228:231], v[64:67], v[148:151], v[228:231]
    ds_read_b128 v[144:147], v242 offset:59392
    buffer_load_dwordx4 v[164:167], v1, s[16:19], s58 offen offset:0 sc1
    buffer_load_dwordx4 v[168:171], v1, s[16:19], s58 offen offset:1024 sc1
    s_waitcnt vmcnt(6)
    v_lshlrev_b32 v24, 16, v248
    v_and_b32 v25, 0xffff0000, v248
    s_waitcnt lgkmcnt(6)
    v_mfma_f32_16x16x32_bf16 v[232:235], v[64:67], v[152:155], v[232:235]
    ds_read_b128 v[148:151], v242 offset:11264
    v_lshlrev_b32 v26, 16, v249
    v_and_b32 v27, 0xffff0000, v249
    s_waitcnt lgkmcnt(6)
    v_mfma_f32_16x16x32_bf16 v[228:231], v[68:71], v[156:159], v[228:231]
    ds_read_b128 v[152:155], v242 offset:44032
    v_lshlrev_b32 v28, 16, v250
    v_and_b32 v29, 0xffff0000, v250
    s_waitcnt lgkmcnt(6)
    v_mfma_f32_16x16x32_bf16 v[232:235], v[68:71], v[160:163], v[232:235]
    ds_read_b128 v[156:159], v242 offset:27648
    v_lshlrev_b32 v30, 16, v251
    v_and_b32 v31, 0xffff0000, v251
    s_waitcnt lgkmcnt(6)
    v_mfma_f32_16x16x32_f16 v[112:115], v[72:75], v[132:135], 0
    ds_read_b128 v[160:163], v242 offset:60416
    v_lshlrev_b32 v40, 16, v130
    v_and_b32 v41, 0xffff0000, v130
    s_waitcnt lgkmcnt(6)
    v_mfma_f32_16x16x32_f16 v[116:119], v[72:75], v[136:139], 0
    ds_read_b128 v[132:135], v243 offset:10240
    v_lshlrev_b32 v42, 16, v131
    v_and_b32 v43, 0xffff0000, v131
    s_waitcnt lgkmcnt(6)
    v_mfma_f32_16x16x32_f16 v[112:115], v[76:79], v[140:143], v[112:115]
    ds_read_b128 v[136:139], v243 offset:43008
    v_lshlrev_b32 v32, 16, v126
    v_and_b32 v33, 0xffff0000, v126
    s_waitcnt lgkmcnt(6)
    v_mfma_f32_16x16x32_f16 v[116:119], v[76:79], v[144:147], v[116:119]
    ds_read_b128 v[140:143], v243 offset:26624
    v_lshlrev_b32 v34, 16, v127
    v_and_b32 v35, 0xffff0000, v127
    s_waitcnt lgkmcnt(6)
    v_mfma_f32_16x16x32_f16 v[112:115], v[244:247], v[148:151], v[112:115]
    ds_read_b128 v[144:147], v243 offset:59392
    v_lshlrev_b32 v36, 16, v128
    v_and_b32 v37, 0xffff0000, v128
    s_waitcnt lgkmcnt(6)
    v_mfma_f32_16x16x32_f16 v[116:119], v[244:247], v[152:155], v[116:119]
    ds_read_b128 v[148:151], v243 offset:11264
    v_lshlrev_b32 v38, 16, v129
    v_and_b32 v39, 0xffff0000, v129
    s_waitcnt lgkmcnt(6)
    v_mfma_f32_16x16x32_f16 v[112:115], v[208:211], v[156:159], v[112:115]
    ds_read_b128 v[152:155], v243 offset:44032
    v_mul_f32 v32, v32, v40
    v_mul_f32 v33, v33, v41
    s_waitcnt lgkmcnt(6)
    v_mfma_f32_16x16x32_f16 v[116:119], v[208:211], v[160:163], v[116:119]
    ds_read_b128 v[156:159], v243 offset:27648
    v_mul_f32 v34, v34, v42
    v_mul_f32 v35, v35, v43
    s_waitcnt lgkmcnt(6)
    v_mfma_f32_16x16x32_f16 v[112:115], v[212:215], v[132:135], v[112:115]
    ds_read_b128 v[160:163], v243 offset:60416
    v_mul_f32 v36, v36, v40
    v_mul_f32 v37, v37, v41
    s_waitcnt lgkmcnt(6)
    v_mfma_f32_16x16x32_f16 v[116:119], v[212:215], v[136:139], v[116:119]
    ds_read_b128 v[132:135], v242 offset:12288
    v_mul_f32 v38, v38, v42
    v_mul_f32 v39, v39, v43
    s_waitcnt lgkmcnt(6)
    v_mfma_f32_16x16x32_f16 v[112:115], v[216:219], v[140:143], v[112:115]
    ds_read_b128 v[136:139], v242 offset:45056
    v_cvt_pk_bf16_f32 v44, v32, v33
    v_cvt_pk_bf16_f32 v45, v34, v35
    s_waitcnt lgkmcnt(6)
    v_mfma_f32_16x16x32_f16 v[116:119], v[216:219], v[144:147], v[116:119]
    ds_read_b128 v[140:143], v242 offset:28672
    v_cvt_pk_bf16_f32 v46, v36, v37
    v_cvt_pk_bf16_f32 v47, v38, v39
    s_waitcnt lgkmcnt(6)
    v_mfma_f32_16x16x32_f16 v[112:115], v[192:195], v[148:151], v[112:115]
    ds_read_b128 v[144:147], v242 offset:61440
    v_lshlrev_b32 v32, 16, v44
    v_and_b32 v33, 0xffff0000, v44
    s_waitcnt lgkmcnt(6)
    v_mfma_f32_16x16x32_f16 v[116:119], v[192:195], v[152:155], v[116:119]
    ds_read_b128 v[148:151], v242 offset:13312
    v_lshlrev_b32 v34, 16, v45
    v_and_b32 v35, 0xffff0000, v45
    s_waitcnt lgkmcnt(6)
    v_mfma_f32_16x16x32_f16 v[112:115], v[196:199], v[156:159], v[112:115]
    ds_read_b128 v[152:155], v242 offset:46080
    v_lshlrev_b32 v36, 16, v46
    v_and_b32 v37, 0xffff0000, v46
    s_waitcnt lgkmcnt(6)
    v_mfma_f32_16x16x32_f16 v[116:119], v[196:199], v[160:163], v[116:119]
    ds_read_b128 v[156:159], v242 offset:29696
    v_lshlrev_b32 v38, 16, v47
    v_and_b32 v39, 0xffff0000, v47
    s_waitcnt lgkmcnt(6)
    v_mfma_f32_16x16x32_f16 v[112:115], v[200:203], v[132:135], v[112:115]
    ds_read_b128 v[160:163], v242 offset:62464
    s_waitcnt lgkmcnt(6)
    v_mfma_f32_16x16x32_f16 v[116:119], v[200:203], v[136:139], v[116:119]
    ds_read_b128 v[132:135], v242 offset:14336
    s_waitcnt lgkmcnt(6)
    v_mfma_f32_16x16x32_f16 v[112:115], v[204:207], v[140:143], v[112:115]
    ds_read_b128 v[136:139], v242 offset:47104
    s_waitcnt lgkmcnt(6)
    v_mfma_f32_16x16x32_f16 v[116:119], v[204:207], v[144:147], v[116:119]
    ds_read_b128 v[140:143], v242 offset:30720
    s_waitcnt lgkmcnt(6)
    v_mfma_f32_16x16x32_f16 v[112:115], v[80:83], v[148:151], v[112:115]
    ds_read_b128 v[144:147], v242 offset:63488
    s_waitcnt lgkmcnt(6)
    v_mfma_f32_16x16x32_f16 v[116:119], v[80:83], v[152:155], v[116:119]
    ds_read_b128 v[148:151], v242 offset:15360
    s_waitcnt lgkmcnt(6)
    v_mfma_f32_16x16x32_f16 v[112:115], v[84:87], v[156:159], v[112:115]
    ds_read_b128 v[152:155], v242 offset:48128
    s_waitcnt lgkmcnt(6)
    v_mfma_f32_16x16x32_f16 v[116:119], v[84:87], v[160:163], v[116:119]
    ds_read_b128 v[156:159], v242 offset:31744
    s_waitcnt lgkmcnt(6)
    v_mfma_f32_16x16x32_f16 v[112:115], v[88:91], v[132:135], v[112:115]
    ds_read_b128 v[160:163], v242 offset:64512
    s_waitcnt lgkmcnt(6)
    v_mfma_f32_16x16x32_f16 v[116:119], v[88:91], v[136:139], v[116:119]
    s_waitcnt lgkmcnt(5)
    v_mfma_f32_16x16x32_f16 v[112:115], v[92:95], v[140:143], v[112:115]
    s_cmp_lt_u32 s34, 4
    s_cbranch_scc1 KF_pye
    buffer_load_dwordx4 v[176:179], v1, s[16:19], s54 offen offset:0 sc1
    buffer_load_dwordx4 v[180:183], v1, s[16:19], s54 offen offset:1024 sc1
KF_pye:
    s_waitcnt lgkmcnt(4)
    v_mfma_f32_16x16x32_f16 v[116:119], v[92:95], v[144:147], v[116:119]
    s_waitcnt lgkmcnt(3)
    v_mfma_f32_16x16x32_f16 v[112:115], v[96:99], v[148:151], v[112:115]
    s_waitcnt lgkmcnt(2)
    v_mfma_f32_16x16x32_f16 v[116:119], v[96:99], v[152:155], v[116:119]
    s_waitcnt lgkmcnt(1)
    v_mfma_f32_16x16x32_f16 v[112:115], v[100:103], v[156:159], v[112:115]
    s_waitcnt lgkmcnt(0)
    v_mfma_f32_16x16x32_f16 v[116:119], v[100:103], v[160:163], v[116:119]
    s_cmp_ge_u32 s34, 4
    s_cbranch_scc1 KF_pyf
    buffer_load_dwordx4 v[176:179], v1, s[16:19], s54 offen offset:0 sc1
    buffer_load_dwordx4 v[180:183], v1, s[16:19], s54 offen offset:1024 sc1
KF_pyf:
    s_waitcnt vmcnt(8) lgkmcnt(0)
    s_movk_i32 s61, 16384
    s_waitcnt vmcnt(2)
KF_pol:
    s_nop 7
    s_nop 3
    v_alignbyte_b32 v172, v164, v172, 1
    v_alignbyte_b32 v173, v168, v173, 1
    v_alignbyte_b32 v172, v165, v172, 1
    v_alignbyte_b32 v173, v169, v173, 1
    v_alignbyte_b32 v172, v166, v172, 1
    v_alignbyte_b32 v173, v170, v173, 1
    v_alignbyte_b32 v172, v167, v172, 1
    v_alignbyte_b32 v173, v171, v173, 1
    v_subrev_u32 v172, s20, v172
    v_subrev_u32 v173, s20, v173
    v_max_u32 v172, v172, v173
    v_cmp_lt_u32 vcc, s22, v172
    s_cbranch_vccz KF_pod
    s_sub_u32 s61, s61, 1
    s_cbranch_scc1 KF_pod
    s_sleep 1
    buffer_load_dwordx4 v[164:167], v1, s[16:19], s58 offen offset:0 sc1
    buffer_load_dwordx4 v[168:171], v1, s[16:19], s58 offen offset:1024 sc1
    s_waitcnt vmcnt(0)
    s_branch KF_pol
KF_st6:
    s_branch KF_ret
KF_pod:
    s_nop 7
    s_nop 3
    v_and_b32 v164, 0xffffff00, v164
    v_and_b32 v165, 0xffffff00, v165
    v_and_b32 v166, 0xffffff00, v166
    v_and_b32 v167, 0xffffff00, v167
    v_and_b32 v168, 0xffffff00, v168
    v_and_b32 v169, 0xffffff00, v169
    v_and_b32 v170, 0xffffff00, v170
    v_and_b32 v171, 0xffffff00, v171
    v_add_f32 v228, v228, v164
    v_add_f32 v229, v229, v165
    v_add_f32 v230, v230, v166
    v_add_f32 v231, v231, v167
    v_add_f32 v232, v232, v168
    v_add_f32 v233, v233, v169
    v_add_f32 v234, v234, v170
    v_add_f32 v235, v235, v171
    v_cvt_pk_bf16_f32 v44, v228, v229
    v_cvt_pk_bf16_f32 v45, v230, v231
    v_cvt_pk_bf16_f32 v46, v232, v233
    v_cvt_pk_bf16_f32 v47, v234, v235
    v_lshlrev_b32 v228, 16, v44
    v_and_b32 v229, 0xffff0000, v44
    v_lshlrev_b32 v230, 16, v45
    v_and_b32 v231, 0xffff0000, v45
    v_lshlrev_b32 v232, 16, v46
    v_and_b32 v233, 0xffff0000, v46
    v_lshlrev_b32 v234, 16, v47
    v_and_b32 v235, 0xffff0000, v47
    v_mul_f32 v120, s53, v228
    v_mul_f32 v121, s53, v229
    v_mul_f32 v122, s53, v230
    v_mul_f32 v123, s53, v231
    v_mul_f32 v124, s53, v232
    v_mul_f32 v125, s53, v233
    v_mul_f32 v126, s53, v234
    v_mul_f32 v127, s53, v235
    v_exp_f32 v120, v120
    v_exp_f32 v121, v121
    v_exp_f32 v122, v122
    v_exp_f32 v123, v123
    v_exp_f32 v124, v124
    v_exp_f32 v125, v125
    v_exp_f32 v126, v126
    v_exp_f32 v127, v127
    v_fma_f32 v32, v112, 2.0, v32
    v_fma_f32 v33, v113, 2.0, v33
    v_fma_f32 v34, v114, 2.0, v34
    v_fma_f32 v35, v115, 2.0, v35
    v_fma_f32 v36, v116, 2.0, v36
    v_fma_f32 v37, v117, 2.0, v37
    v_fma_f32 v38, v118, 2.0, v38
    v_fma_f32 v39, v119, 2.0, v39
    v_add_f32 v120, 1.0, v120
    v_add_f32 v121, 1.0, v121
    v_add_f32 v122, 1.0, v122
    v_add_f32 v123, 1.0, v123
    v_add_f32 v124, 1.0, v124
    v_add_f32 v125, 1.0, v125
    v_add_f32 v126, 1.0, v126
    v_add_f32 v127, 1.0, v127
    v_rcp_f32 v120, v120
    v_rcp_f32 v121, v121
    v_rcp_f32 v122, v122
    v_rcp_f32 v123, v123
    v_rcp_f32 v124, v124
    v_rcp_f32 v125, v125
    v_rcp_f32 v126, v126
    v_rcp_f32 v127, v127
    v_mul_f32 v228, v228, v120
    v_mul_f32 v229, v229, v121
    v_mul_f32 v230, v230, v122
    v_mul_f32 v231, v231, v123
    v_mul_f32 v232, v232, v124
    v_mul_f32 v233, v233, v125
    v_mul_f32 v234, v234, v126
    v_mul_f32 v235, v235, v127
    v_cvt_pk_bf16_f32 v44, v228, v229
    v_cvt_pk_bf16_f32 v45, v230, v231
    v_cvt_pk_bf16_f32 v46, v232, v233
    v_cvt_pk_bf16_f32 v47, v234, v235
    v_lshlrev_b32 v228, 16, v44
    v_and_b32 v229, 0xffff0000, v44
    v_lshlrev_b32 v230, 16, v45
    v_and_b32 v231, 0xffff0000, v45
    v_lshlrev_b32 v232, 16, v46
    v_and_b32 v233, 0xffff0000, v46
    v_lshlrev_b32 v234, 16, v47
    v_and_b32 v235, 0xffff0000, v47
    s_movk_i32 s61, 16384
    s_waitcnt vmcnt(0)
KF_pyl:
    s_nop 7
    s_nop 3
    v_alignbyte_b32 v184, v176, v184, 1
    v_alignbyte_b32 v185, v180, v185, 1
    v_alignbyte_b32 v184, v177, v184, 1
    v_alignbyte_b32 v185, v181, v185, 1
    v_alignbyte_b32 v184, v178, v184, 1
    v_alignbyte_b32 v185, v182, v185, 1
    v_alignbyte_b32 v184, v179, v184, 1
    v_alignbyte_b32 v185, v183, v185, 1
    v_subrev_u32 v184, s20, v184
    v_subrev_u32 v185, s20, v185
    v_max_u32 v184, v184, v185
    v_cmp_lt_u32 vcc, s22, v184
    s_cbranch_vccz KF_pyd
    s_sub_u32 s61, s61, 1
    s_cbranch_scc1 KF_pyd
    s_sleep 1
    buffer_load_dwordx4 v[176:179], v1, s[16:19], s54 offen offset:0 sc1
    buffer_load_dwordx4 v[180:183], v1, s[16:19], s54 offen offset:1024 sc1
    s_waitcnt vmcnt(0)
    s_branch KF_pyl
KF_st7:
    s_branch KF_ret
KF_pyd:
    s_nop 7
    s_nop 3
    v_and_b32 v176, 0xffffff00, v176
    v_and_b32 v177, 0xffffff00, v177
    v_and_b32 v178, 0xffffff00, v178
    v_and_b32 v179, 0xffffff00, v179
    v_and_b32 v180, 0xffffff00, v180
    v_and_b32 v181, 0xffffff00, v181
    v_and_b32 v182, 0xffffff00, v182
    v_and_b32 v183, 0xffffff00, v183
    v_fma_f32 v132, v176, 2.0, v32
    v_fma_f32 v133, v177, 2.0, v33
    v_fma_f32 v134, v178, 2.0, v34
    v_fma_f32 v135, v179, 2.0, v35
    v_fma_f32 v136, v180, 2.0, v36
    v_fma_f32 v137, v181, 2.0, v37
    v_fma_f32 v138, v182, 2.0, v38
    v_fma_f32 v139, v183, 2.0, v39
    v_mul_f32 v132, v132, v228
    v_mul_f32 v133, v133, v229
    v_mul_f32 v134, v134, v230
    v_mul_f32 v135, v135, v231
    v_mul_f32 v136, v136, v232
    v_mul_f32 v137, v137, v233
    v_mul_f32 v138, v138, v234
    v_mul_f32 v139, v139, v235
    v_add_f32 v132, v132, v24
    v_add_f32 v133, v133, v25
    v_add_f32 v134, v134, v26
    v_add_f32 v135, v135, v27
    v_add_f32 v136, v136, v28
    v_add_f32 v137, v137, v29
    v_add_f32 v138, v138, v30
    v_add_f32 v139, v139, v31
    s_mov_b32 s48, 32768
    buffer_store_dwordx4 v[132:135], v12, s[8:11], 0 offen
    buffer_store_dwordx4 v[136:139], v12, s[8:11], s48 offen
    s_endpgm
KF_st8:
    s_branch KF_ret
KF_done:
    s_nop 7
    s_nop 3
    s_endpgm
.section .rodata,"a"
.p2align 6
.amdhsa_kernel recurrent_scan__ssm_conv_s5__dense_activation_silu__prompt_kernel
  .amdhsa_next_free_vgpr 256
  .amdhsa_next_free_sgpr 102
  .amdhsa_accum_offset 256
  .amdhsa_group_segment_fixed_size 0
  .amdhsa_kernarg_size 120
  .amdhsa_user_sgpr_count 2
  .amdhsa_user_sgpr_kernarg_segment_ptr 1
  .amdhsa_system_sgpr_workgroup_id_x 1
.end_amdhsa_kernel
```
